```python
import torch

def _softmax(x, axis=-1):
    return torch.softmax(x, dim=axis)

def _gelu(x):
    return torch.nn.functional.gelu(x, approximate='tanh')

def _silu(x):
    return torch.nn.functional.silu(x)

def _sigmoid(x):
    return torch.sigmoid(x)

def _layernorm(x, axis=-1, eps=1e-05):
    m = x.mean(dim=axis, keepdim=True)
    v = x.var(dim=axis, keepdim=True, unbiased=False)
    return (x - m) / torch.sqrt(v + eps)

def _scatter_add(tgt, idx, src, axis=0):
    return tgt.clone().index_add_(axis, idx, src)

def _segment_sum(src, seg, n):
    out = torch.zeros((n,) + src.shape[1:], dtype=src.dtype)
    return out.index_add_(0, seg, src)

def _pad(x, pw):
    flat = tuple((v for pair in reversed(pw) for v in pair))
    return torch.nn.functional.pad(x, flat)
kernel_name = 'standalone__tree_speculative_verify_tree_attention_over_candidate_token_tree__decode'

def setup_inputs():

    _w = lambda a: (lambda t: t.to(torch.bfloat16) if t.is_floating_point() else t)(torch.as_tensor(a))
    B, Hq, Hkv, T, C, D = (4, 32, 32, 1, 8192, 128)
    tree_mask = torch.zeros((B, T, T), dtype=float)
    for b in range(B):
        parent = torch.zeros(T, dtype=torch.int64)
        for i in range(1, T):
            parent[i] = int(torch.randint(0, i, (1,)).item())
        for i in range(T):
            j = i
            tree_mask[b, i, j] = 1.0
            while j > 0:
                j = parent[j]
                tree_mask[b, i, j] = 1.0
    return {'q': _w((lambda *s: torch.randn(*s, dtype=torch.bfloat16) * 0.8)(B, Hq, T, D)), 'k_cache': _w((lambda *s: torch.randn(*s, dtype=torch.bfloat16) * 0.8)(B, Hkv, C, D)), 'v_cache': _w((lambda *s: torch.randn(*s, dtype=torch.bfloat16) * 0.05)(B, Hkv, C, D)), 'k_tree': _w((lambda *s: torch.randn(*s, dtype=torch.bfloat16) * 0.8)(B, Hkv, T, D)), 'v_tree': _w((lambda *s: torch.randn(*s, dtype=torch.bfloat16) * 0.05)(B, Hkv, T, D)), 'tree_mask': _w(tree_mask)}

def reference(q, k_cache, v_cache, k_tree, v_tree, tree_mask):
    B, Hq, T, D = q.shape
    Hkv, C = (k_cache.shape[1], k_cache.shape[2])
    rep = Hq // Hkv
    kc = (lambda x, n, axis: torch.repeat_interleave(x, n, dim=axis))(k_cache, rep, axis=1)
    vc = (lambda x, n, axis: torch.repeat_interleave(x, n, dim=axis))(v_cache, rep, axis=1)
    kt = (lambda x, n, axis: torch.repeat_interleave(x, n, dim=axis))(k_tree, rep, axis=1)
    vt = (lambda x, n, axis: torch.repeat_interleave(x, n, dim=axis))(v_tree, rep, axis=1)
    k = torch.concatenate([kc, kt], axis=2)
    v = torch.concatenate([vc, vt], axis=2)
    scale = D ** (-0.5)
    scores = torch.einsum('bhqd,bhkd->bhqk', q, k) * scale
    ctx_mask = torch.ones((B, 1, T, C), dtype=scores.dtype)
    tm = tree_mask[:, None, :, :].clone()
    full_mask = torch.concatenate([ctx_mask, tm], axis=-1)
    scores = scores + (1.0 - full_mask) * -1000000000.0
    p = _softmax(scores, axis=-1)
    return torch.einsum('bhqk,bhkd->bhqd', p, v)
```

```asm
; @launch grid=(256,1,1) block=(128,1,1) lds=5120
.amdgcn_target "amdgcn-amd-amdhsa--gfx950"
.text
.globl standalone__tree_speculative_verify_tree_attention_over_candidate_token_tree__decode_kernel
.p2align 8
.type standalone__tree_speculative_verify_tree_attention_over_candidate_token_tree__decode_kernel,@function
standalone__tree_speculative_verify_tree_attention_over_candidate_token_tree__decode_kernel:
    s_cmp_ge_u32 s2, 256
    s_cbranch_scc1 L_end
    v_readfirstlane_b32 s58, v0
    s_load_dwordx16 s[24:39], s[0:1], 0
    s_lshr_b32 s42, s2, 3
    s_and_b32 s43, s2, 7
    s_lshl_b32 s64, s42, 2
    s_cmp_ge_u32 s58, 64
    s_cbranch_scc1 L_helper
    v_lshlrev_b32 v1, 4, v0
    s_lshl_b32 s51, s42, 23
    s_and_b32 s69, s42, 3
    s_lshl_b32 s46, s69, 21
    s_lshl_b32 s52, s43, 15
    s_add_u32 s46, s46, s52
    v_add_u32 v2, 4096, v1
    v_add_u32 v3, 8192, v1
    v_add_u32 v4, 12288, v1
    v_and_b32 v40, 15, v0
    v_lshlrev_b32 v41, 4, v40
    s_add_u32 s52, s64, s69
    s_lshl_b32 s52, s52, 8
    v_add_u32 v42, s52, v41
    s_add_u32 s52, s42, 1
    s_and_b32 s52, s52, 3
    s_add_u32 s52, s52, s64
    s_lshl_b32 s52, s52, 8
    v_add_u32 v43, s52, v41
    s_mov_b32 s48, s46
    s_add_u32 s49, s46, 16384
    s_waitcnt lgkmcnt(0)
    s_add_u32 s4, s26, s51
    s_addc_u32 s5, s27, 0
    s_and_b32 s5, s5, 0xffff
    s_mov_b32 s16, s4
    s_mov_b32 s17, s5
    s_mov_b32 s18, 0x800000
    s_mov_b32 s19, 0x00020000
    s_mov_b32 s20, s4
    s_mov_b32 s21, s5
    s_mov_b32 s22, 0x800000
    s_mov_b32 s23, 0x00020000
    global_load_dwordx4 v[8:11], v42, s[24:25]
    buffer_load_dwordx4 v[64:67], v1, s[16:19], s48 offen offset:0 nt
    buffer_load_dwordx4 v[68:71], v1, s[16:19], s48 offen offset:1024 nt
    buffer_load_dwordx4 v[72:75], v1, s[16:19], s48 offen offset:2048 nt
    buffer_load_dwordx4 v[76:79], v1, s[16:19], s48 offen offset:3072 nt
    buffer_load_dwordx4 v[80:83], v2, s[16:19], s48 offen offset:0 nt
    buffer_load_dwordx4 v[84:87], v2, s[16:19], s48 offen offset:1024 nt
    buffer_load_dwordx4 v[88:91], v2, s[16:19], s48 offen offset:2048 nt
    buffer_load_dwordx4 v[92:95], v2, s[16:19], s48 offen offset:3072 nt
    buffer_load_dwordx4 v[96:99], v3, s[16:19], s48 offen offset:0 nt
    buffer_load_dwordx4 v[100:103], v3, s[16:19], s48 offen offset:1024 nt
    buffer_load_dwordx4 v[104:107], v3, s[16:19], s48 offen offset:2048 nt
    buffer_load_dwordx4 v[108:111], v3, s[16:19], s48 offen offset:3072 nt
    buffer_load_dwordx4 v[112:115], v4, s[16:19], s48 offen offset:0 nt
    buffer_load_dwordx4 v[116:119], v4, s[16:19], s48 offen offset:1024 nt
    buffer_load_dwordx4 v[120:123], v4, s[16:19], s48 offen offset:2048 nt
    buffer_load_dwordx4 v[124:127], v4, s[16:19], s48 offen offset:3072 nt
    buffer_load_dwordx4 v[128:131], v1, s[20:23], s49 offen offset:0 nt
    buffer_load_dwordx4 v[132:135], v1, s[20:23], s49 offen offset:1024 nt
    buffer_load_dwordx4 v[136:139], v1, s[20:23], s49 offen offset:2048 nt
    buffer_load_dwordx4 v[140:143], v1, s[20:23], s49 offen offset:3072 nt
    buffer_load_dwordx4 v[144:147], v2, s[20:23], s49 offen offset:0 nt
    global_load_dwordx4 v[12:15], v43, s[24:25]
    s_load_dwordx2 s[40:41], s[0:1], 64
    s_add_u32 s8, s28, s51
    s_addc_u32 s9, s29, 0
    s_and_b32 s9, s9, 0xffff
    s_mov_b32 s12, s4
    s_mov_b32 s13, s5
    s_mov_b32 s14, 0x800000
    s_mov_b32 s15, 0x00020000
    s_mov_b32 s47, s49
    s_add_u32 s52, s69, 3
    s_and_b32 s52, s52, 3
    s_lshl_b32 s70, s52, 21
    s_mov_b32 s50, 0x3e0293ee
    s_mov_b32 s60, 0xcccccccc
    s_mov_b32 s61, 0xcccccccc
    s_mov_b32 s62, 0xaaaaaaaa
    s_mov_b32 s63, 0xaaaaaaaa
    s_mov_b32 s44, 0
    s_mov_b32 s45, 0
    s_mov_b32 s55, 8
    v_lshlrev_b32 v55, 2, v0
    v_mov_b32 v54, 0xff800000
    v_lshrrev_b32 v44, 4, v0
    v_lshl_add_u32 v7, v40, 2, v44
    v_lshlrev_b32 v7, 2, v7
    v_mov_b32 v6, 0
    v_mov_b32 v16, 0
    v_mov_b32 v17, 0
    v_mov_b32 v18, 0
    v_mov_b32 v19, 0
    v_mov_b32 v20, 0
    v_mov_b32 v21, 0
    v_mov_b32 v22, 0
    v_mov_b32 v23, 0
    .p2align 6
L_k:
    s_waitcnt vmcnt(19)
    buffer_load_dwordx4 v[148:151], v2, s[12:15], s47 offen offset:1024 nt
    buffer_load_dwordx4 v[152:155], v2, s[12:15], s47 offen offset:2048 nt
    s_add_u32 s52, s45, 1
    s_cmp_eq_u32 s52, s55
    s_cselect_b32 s16, s8, s4
    s_cselect_b32 s17, s9, s5
    s_cselect_b32 s53, 0, s52
    s_lshl_b32 s53, s53, 18
    s_add_u32 s48, s46, s53
    s_mov_b32 s20, s16
    s_mov_b32 s21, s17
    s_add_u32 s49, s48, 16384
    v_dot2_f32_bf16 v24, v64, v8, 0
    v_dot2_f32_bf16 v25, v68, v8, 0
    v_dot2_f32_bf16 v24, v65, v9, v24
    v_dot2_f32_bf16 v25, v69, v9, v25
    v_dot2_f32_bf16 v24, v66, v10, v24
    v_dot2_f32_bf16 v25, v70, v10, v25
    v_dot2_f32_bf16 v24, v67, v11, v24
    v_dot2_f32_bf16 v25, v71, v11, v25
    s_waitcnt vmcnt(19)
    buffer_load_dwordx4 v[156:159], v2, s[12:15], s47 offen offset:3072 nt
    buffer_load_dwordx4 v[160:163], v3, s[12:15], s47 offen offset:0 nt
    v_dot2_f32_bf16 v26, v72, v8, 0
    v_dot2_f32_bf16 v27, v76, v8, 0
    v_dot2_f32_bf16 v26, v73, v9, v26
    v_dot2_f32_bf16 v27, v77, v9, v27
    v_dot2_f32_bf16 v26, v74, v10, v26
    v_dot2_f32_bf16 v27, v78, v10, v27
    v_dot2_f32_bf16 v26, v75, v11, v26
    v_dot2_f32_bf16 v27, v79, v11, v27
    v_add_f32_dpp v24, v24, v24 row_ror:8 row_mask:0xf bank_mask:0x3
    v_add_f32_dpp v24, v25, v25 row_ror:8 row_mask:0xf bank_mask:0xc
    s_waitcnt vmcnt(19)
    buffer_load_dwordx4 v[164:167], v3, s[12:15], s47 offen offset:1024 nt
    buffer_load_dwordx4 v[168:171], v3, s[12:15], s47 offen offset:2048 nt
    v_dot2_f32_bf16 v28, v80, v8, 0
    v_dot2_f32_bf16 v29, v84, v8, 0
    v_dot2_f32_bf16 v28, v81, v9, v28
    v_dot2_f32_bf16 v29, v85, v9, v29
    v_dot2_f32_bf16 v28, v82, v10, v28
    v_dot2_f32_bf16 v29, v86, v10, v29
    v_dot2_f32_bf16 v28, v83, v11, v28
    v_dot2_f32_bf16 v29, v87, v11, v29
    v_add_f32_dpp v26, v26, v26 row_ror:8 row_mask:0xf bank_mask:0x3
    v_add_f32_dpp v26, v27, v27 row_ror:8 row_mask:0xf bank_mask:0xc
    s_waitcnt vmcnt(19)
    buffer_load_dwordx4 v[172:175], v3, s[12:15], s47 offen offset:3072 nt
    buffer_load_dwordx4 v[176:179], v4, s[12:15], s47 offen offset:0 nt
    v_dot2_f32_bf16 v30, v88, v8, 0
    v_dot2_f32_bf16 v31, v92, v8, 0
    v_dot2_f32_bf16 v30, v89, v9, v30
    v_dot2_f32_bf16 v31, v93, v9, v31
    v_dot2_f32_bf16 v30, v90, v10, v30
    v_dot2_f32_bf16 v31, v94, v10, v31
    v_dot2_f32_bf16 v30, v91, v11, v30
    v_dot2_f32_bf16 v31, v95, v11, v31
    v_add_f32_dpp v28, v28, v28 row_ror:8 row_mask:0xf bank_mask:0x3
    v_add_f32_dpp v28, v29, v29 row_ror:8 row_mask:0xf bank_mask:0xc
    v_add_f32_dpp v24, v24, v24 row_shl:4 row_mask:0xf bank_mask:0x5
    v_add_f32_dpp v24, v26, v26 row_shr:4 row_mask:0xf bank_mask:0xa
    s_waitcnt vmcnt(19)
    buffer_load_dwordx4 v[180:183], v4, s[12:15], s47 offen offset:1024 nt
    buffer_load_dwordx4 v[184:187], v4, s[12:15], s47 offen offset:2048 nt
    v_dot2_f32_bf16 v32, v96, v8, 0
    v_dot2_f32_bf16 v33, v100, v8, 0
    v_dot2_f32_bf16 v32, v97, v9, v32
    v_dot2_f32_bf16 v33, v101, v9, v33
    v_dot2_f32_bf16 v32, v98, v10, v32
    v_dot2_f32_bf16 v33, v102, v10, v33
    v_dot2_f32_bf16 v32, v99, v11, v32
    v_dot2_f32_bf16 v33, v103, v11, v33
    v_add_f32_dpp v30, v30, v30 row_ror:8 row_mask:0xf bank_mask:0x3
    v_add_f32_dpp v30, v31, v31 row_ror:8 row_mask:0xf bank_mask:0xc
    s_waitcnt vmcnt(19)
    buffer_load_dwordx4 v[188:191], v4, s[12:15], s47 offen offset:3072 nt
    buffer_load_dwordx4 v[64:67], v1, s[16:19], s48 offen offset:0 nt
    v_dot2_f32_bf16 v34, v104, v8, 0
    v_dot2_f32_bf16 v35, v108, v8, 0
    v_dot2_f32_bf16 v34, v105, v9, v34
    v_dot2_f32_bf16 v35, v109, v9, v35
    v_dot2_f32_bf16 v34, v106, v10, v34
    v_dot2_f32_bf16 v35, v110, v10, v35
    v_dot2_f32_bf16 v34, v107, v11, v34
    v_dot2_f32_bf16 v35, v111, v11, v35
    v_add_f32_dpp v32, v32, v32 row_ror:8 row_mask:0xf bank_mask:0x3
    v_add_f32_dpp v32, v33, v33 row_ror:8 row_mask:0xf bank_mask:0xc
    v_add_f32_dpp v28, v28, v28 row_shl:4 row_mask:0xf bank_mask:0x5
    v_add_f32_dpp v28, v30, v30 row_shr:4 row_mask:0xf bank_mask:0xa
    s_waitcnt vmcnt(19)
    buffer_load_dwordx4 v[68:71], v1, s[16:19], s48 offen offset:1024 nt
    buffer_load_dwordx4 v[72:75], v1, s[16:19], s48 offen offset:2048 nt
    v_dot2_f32_bf16 v36, v112, v8, 0
    v_dot2_f32_bf16 v37, v116, v8, 0
    v_dot2_f32_bf16 v36, v113, v9, v36
    v_dot2_f32_bf16 v37, v117, v9, v37
    v_dot2_f32_bf16 v36, v114, v10, v36
    v_dot2_f32_bf16 v37, v118, v10, v37
    v_dot2_f32_bf16 v36, v115, v11, v36
    v_dot2_f32_bf16 v37, v119, v11, v37
    v_add_f32_dpp v34, v34, v34 row_ror:8 row_mask:0xf bank_mask:0x3
    v_add_f32_dpp v34, v35, v35 row_ror:8 row_mask:0xf bank_mask:0xc
    v_add_f32_dpp v40, v24, v24 quad_perm:[2,3,0,1] row_mask:0xf bank_mask:0xf
    v_add_f32_dpp v41, v28, v28 quad_perm:[2,3,0,1] row_mask:0xf bank_mask:0xf
    v_cndmask_b32 v24, v40, v41, s[60:61]
    s_waitcnt vmcnt(19)
    buffer_load_dwordx4 v[76:79], v1, s[16:19], s48 offen offset:3072 nt
    buffer_load_dwordx4 v[80:83], v2, s[16:19], s48 offen offset:0 nt
    v_dot2_f32_bf16 v38, v120, v8, 0
    v_dot2_f32_bf16 v39, v124, v8, 0
    v_dot2_f32_bf16 v38, v121, v9, v38
    v_dot2_f32_bf16 v39, v125, v9, v39
    v_dot2_f32_bf16 v38, v122, v10, v38
    v_dot2_f32_bf16 v39, v126, v10, v39
    v_dot2_f32_bf16 v38, v123, v11, v38
    v_dot2_f32_bf16 v39, v127, v11, v39
    v_add_f32_dpp v36, v36, v36 row_ror:8 row_mask:0xf bank_mask:0x3
    v_add_f32_dpp v36, v37, v37 row_ror:8 row_mask:0xf bank_mask:0xc
    v_add_f32_dpp v32, v32, v32 row_shl:4 row_mask:0xf bank_mask:0x5
    v_add_f32_dpp v32, v34, v34 row_shr:4 row_mask:0xf bank_mask:0xa
    v_add_f32_dpp v38, v38, v38 row_ror:8 row_mask:0xf bank_mask:0x3
    v_add_f32_dpp v38, v39, v39 row_ror:8 row_mask:0xf bank_mask:0xc
    v_add_f32_dpp v36, v36, v36 row_shl:4 row_mask:0xf bank_mask:0x5
    s_nop 0
    v_add_f32_dpp v36, v38, v38 row_shr:4 row_mask:0xf bank_mask:0xa
    v_add_f32_dpp v40, v32, v32 quad_perm:[2,3,0,1] row_mask:0xf bank_mask:0xf
    s_nop 0
    v_add_f32_dpp v41, v36, v36 quad_perm:[2,3,0,1] row_mask:0xf bank_mask:0xf
    v_cndmask_b32 v32, v40, v41, s[60:61]
    v_add_f32_dpp v40, v24, v24 quad_perm:[1,0,3,2] row_mask:0xf bank_mask:0xf
    s_nop 0
    v_add_f32_dpp v41, v32, v32 quad_perm:[1,0,3,2] row_mask:0xf bank_mask:0xf
    v_cndmask_b32 v40, v40, v41, s[62:63]
    v_mul_f32 v40, s50, v40
    v_max_f32 v54, v54, v40
    ds_write_b32 v55, v40 offset:0
    s_waitcnt vmcnt(19)
    buffer_load_dwordx4 v[84:87], v2, s[16:19], s48 offen offset:1024 nt
    buffer_load_dwordx4 v[88:91], v2, s[16:19], s48 offen offset:2048 nt
    v_dot2_f32_bf16 v24, v128, v8, 0
    v_dot2_f32_bf16 v25, v132, v8, 0
    v_dot2_f32_bf16 v24, v129, v9, v24
    v_dot2_f32_bf16 v25, v133, v9, v25
    v_dot2_f32_bf16 v24, v130, v10, v24
    v_dot2_f32_bf16 v25, v134, v10, v25
    v_dot2_f32_bf16 v24, v131, v11, v24
    v_dot2_f32_bf16 v25, v135, v11, v25
    s_waitcnt vmcnt(19)
    buffer_load_dwordx4 v[92:95], v2, s[16:19], s48 offen offset:3072 nt
    buffer_load_dwordx4 v[96:99], v3, s[16:19], s48 offen offset:0 nt
    v_dot2_f32_bf16 v26, v136, v8, 0
    v_dot2_f32_bf16 v27, v140, v8, 0
    v_dot2_f32_bf16 v26, v137, v9, v26
    v_dot2_f32_bf16 v27, v141, v9, v27
    v_dot2_f32_bf16 v26, v138, v10, v26
    v_dot2_f32_bf16 v27, v142, v10, v27
    v_dot2_f32_bf16 v26, v139, v11, v26
    v_dot2_f32_bf16 v27, v143, v11, v27
    v_add_f32_dpp v24, v24, v24 row_ror:8 row_mask:0xf bank_mask:0x3
    v_add_f32_dpp v24, v25, v25 row_ror:8 row_mask:0xf bank_mask:0xc
    s_waitcnt vmcnt(19)
    buffer_load_dwordx4 v[100:103], v3, s[16:19], s48 offen offset:1024 nt
    buffer_load_dwordx4 v[104:107], v3, s[16:19], s48 offen offset:2048 nt
    v_dot2_f32_bf16 v28, v144, v8, 0
    v_dot2_f32_bf16 v29, v148, v8, 0
    v_dot2_f32_bf16 v28, v145, v9, v28
    v_dot2_f32_bf16 v29, v149, v9, v29
    v_dot2_f32_bf16 v28, v146, v10, v28
    v_dot2_f32_bf16 v29, v150, v10, v29
    v_dot2_f32_bf16 v28, v147, v11, v28
    v_dot2_f32_bf16 v29, v151, v11, v29
    v_add_f32_dpp v26, v26, v26 row_ror:8 row_mask:0xf bank_mask:0x3
    v_add_f32_dpp v26, v27, v27 row_ror:8 row_mask:0xf bank_mask:0xc
    s_waitcnt vmcnt(19)
    buffer_load_dwordx4 v[108:111], v3, s[16:19], s48 offen offset:3072 nt
    buffer_load_dwordx4 v[112:115], v4, s[16:19], s48 offen offset:0 nt
    v_dot2_f32_bf16 v30, v152, v8, 0
    v_dot2_f32_bf16 v31, v156, v8, 0
    v_dot2_f32_bf16 v30, v153, v9, v30
    v_dot2_f32_bf16 v31, v157, v9, v31
    v_dot2_f32_bf16 v30, v154, v10, v30
    v_dot2_f32_bf16 v31, v158, v10, v31
    v_dot2_f32_bf16 v30, v155, v11, v30
    v_dot2_f32_bf16 v31, v159, v11, v31
    v_add_f32_dpp v28, v28, v28 row_ror:8 row_mask:0xf bank_mask:0x3
    v_add_f32_dpp v28, v29, v29 row_ror:8 row_mask:0xf bank_mask:0xc
    v_add_f32_dpp v24, v24, v24 row_shl:4 row_mask:0xf bank_mask:0x5
    v_add_f32_dpp v24, v26, v26 row_shr:4 row_mask:0xf bank_mask:0xa
    s_waitcnt vmcnt(19)
    buffer_load_dwordx4 v[116:119], v4, s[16:19], s48 offen offset:1024 nt
    buffer_load_dwordx4 v[120:123], v4, s[16:19], s48 offen offset:2048 nt
    v_dot2_f32_bf16 v32, v160, v8, 0
    v_dot2_f32_bf16 v33, v164, v8, 0
    v_dot2_f32_bf16 v32, v161, v9, v32
    v_dot2_f32_bf16 v33, v165, v9, v33
    v_dot2_f32_bf16 v32, v162, v10, v32
    v_dot2_f32_bf16 v33, v166, v10, v33
    v_dot2_f32_bf16 v32, v163, v11, v32
    v_dot2_f32_bf16 v33, v167, v11, v33
    v_add_f32_dpp v30, v30, v30 row_ror:8 row_mask:0xf bank_mask:0x3
    v_add_f32_dpp v30, v31, v31 row_ror:8 row_mask:0xf bank_mask:0xc
    s_waitcnt vmcnt(19)
    buffer_load_dwordx4 v[124:127], v4, s[16:19], s48 offen offset:3072 nt
    buffer_load_dwordx4 v[128:131], v1, s[20:23], s49 offen offset:0 nt
    v_dot2_f32_bf16 v34, v168, v8, 0
    v_dot2_f32_bf16 v35, v172, v8, 0
    v_dot2_f32_bf16 v34, v169, v9, v34
    v_dot2_f32_bf16 v35, v173, v9, v35
    v_dot2_f32_bf16 v34, v170, v10, v34
    v_dot2_f32_bf16 v35, v174, v10, v35
    v_dot2_f32_bf16 v34, v171, v11, v34
    v_dot2_f32_bf16 v35, v175, v11, v35
    v_add_f32_dpp v32, v32, v32 row_ror:8 row_mask:0xf bank_mask:0x3
    v_add_f32_dpp v32, v33, v33 row_ror:8 row_mask:0xf bank_mask:0xc
    v_add_f32_dpp v28, v28, v28 row_shl:4 row_mask:0xf bank_mask:0x5
    v_add_f32_dpp v28, v30, v30 row_shr:4 row_mask:0xf bank_mask:0xa
    s_waitcnt vmcnt(19)
    buffer_load_dwordx4 v[132:135], v1, s[20:23], s49 offen offset:1024 nt
    buffer_load_dwordx4 v[136:139], v1, s[20:23], s49 offen offset:2048 nt
    v_dot2_f32_bf16 v36, v176, v8, 0
    v_dot2_f32_bf16 v37, v180, v8, 0
    v_dot2_f32_bf16 v36, v177, v9, v36
    v_dot2_f32_bf16 v37, v181, v9, v37
    v_dot2_f32_bf16 v36, v178, v10, v36
    v_dot2_f32_bf16 v37, v182, v10, v37
    v_dot2_f32_bf16 v36, v179, v11, v36
    v_dot2_f32_bf16 v37, v183, v11, v37
    v_add_f32_dpp v34, v34, v34 row_ror:8 row_mask:0xf bank_mask:0x3
    v_add_f32_dpp v34, v35, v35 row_ror:8 row_mask:0xf bank_mask:0xc
    v_add_f32_dpp v40, v24, v24 quad_perm:[2,3,0,1] row_mask:0xf bank_mask:0xf
    v_add_f32_dpp v41, v28, v28 quad_perm:[2,3,0,1] row_mask:0xf bank_mask:0xf
    v_cndmask_b32 v24, v40, v41, s[60:61]
    s_waitcnt vmcnt(19)
    buffer_load_dwordx4 v[140:143], v1, s[20:23], s49 offen offset:3072 nt
    buffer_load_dwordx4 v[144:147], v2, s[20:23], s49 offen offset:0 nt
    v_dot2_f32_bf16 v38, v184, v8, 0
    v_dot2_f32_bf16 v39, v188, v8, 0
    v_dot2_f32_bf16 v38, v185, v9, v38
    v_dot2_f32_bf16 v39, v189, v9, v39
    v_dot2_f32_bf16 v38, v186, v10, v38
    v_dot2_f32_bf16 v39, v190, v10, v39
    v_dot2_f32_bf16 v38, v187, v11, v38
    v_dot2_f32_bf16 v39, v191, v11, v39
    v_add_f32_dpp v36, v36, v36 row_ror:8 row_mask:0xf bank_mask:0x3
    v_add_f32_dpp v36, v37, v37 row_ror:8 row_mask:0xf bank_mask:0xc
    v_add_f32_dpp v32, v32, v32 row_shl:4 row_mask:0xf bank_mask:0x5
    v_add_f32_dpp v32, v34, v34 row_shr:4 row_mask:0xf bank_mask:0xa
    v_add_f32_dpp v38, v38, v38 row_ror:8 row_mask:0xf bank_mask:0x3
    v_add_f32_dpp v38, v39, v39 row_ror:8 row_mask:0xf bank_mask:0xc
    v_add_f32_dpp v36, v36, v36 row_shl:4 row_mask:0xf bank_mask:0x5
    s_nop 0
    v_add_f32_dpp v36, v38, v38 row_shr:4 row_mask:0xf bank_mask:0xa
    v_add_f32_dpp v40, v32, v32 quad_perm:[2,3,0,1] row_mask:0xf bank_mask:0xf
    s_nop 0
    v_add_f32_dpp v41, v36, v36 quad_perm:[2,3,0,1] row_mask:0xf bank_mask:0xf
    v_cndmask_b32 v32, v40, v41, s[60:61]
    v_add_f32_dpp v40, v24, v24 quad_perm:[1,0,3,2] row_mask:0xf bank_mask:0xf
    s_nop 0
    v_add_f32_dpp v41, v32, v32 quad_perm:[1,0,3,2] row_mask:0xf bank_mask:0xf
    v_cndmask_b32 v40, v40, v41, s[62:63]
    v_mul_f32 v40, s50, v40
    v_max_f32 v54, v54, v40
    ds_write_b32 v55, v40 offset:256
    v_add_u32 v55, 512, v55
    s_mov_b32 s12, s20
    s_mov_b32 s13, s21
    s_mov_b32 s47, s49
    s_add_u32 s45, s45, 1
    s_cmp_lg_u32 s45, s55
    s_cbranch_scc1 L_k
    s_mov_b32 s45, 0
    v_lshlrev_b32 v55, 2, v0
    v_max_f32_dpp v5, v54, v54 row_ror:8 row_mask:0xf bank_mask:0xf
    ds_read_b32 v56, v55
    ds_read_b32 v57, v55 offset:256
    v_max_f32_dpp v5, v5, v5 row_ror:4 row_mask:0xf bank_mask:0xf
    s_nop 1
    v_max_f32_dpp v5, v5, v5 row_ror:2 row_mask:0xf bank_mask:0xf
    s_nop 1
    v_max_f32_dpp v5, v5, v5 row_ror:1 row_mask:0xf bank_mask:0xf
    v_mov_b32 v54, 0xff800000
    .p2align 6
L_v:
    s_waitcnt vmcnt(19)
    buffer_load_dwordx4 v[148:151], v2, s[12:15], s47 offen offset:1024 nt
    buffer_load_dwordx4 v[152:155], v2, s[12:15], s47 offen offset:2048 nt
    s_add_u32 s52, s45, 1
    s_cmp_eq_u32 s52, s55
    s_cbranch_scc1 L_v_last
    s_mov_b32 s16, s8
    s_mov_b32 s17, s9
    s_mov_b32 s20, s8
    s_mov_b32 s21, s9
    s_lshl_b32 s53, s52, 18
    s_add_u32 s48, s46, s53
    s_add_u32 s49, s48, 16384
    s_branch L_v_go
L_v_last:
    s_mov_b32 s16, s4
    s_mov_b32 s17, s5
    s_cmp_eq_u32 s44, 3
    s_cbranch_scc1 L_v_last2
    s_mov_b32 s20, s4
    s_mov_b32 s21, s5
    s_add_u32 s52, s69, 1
    s_and_b32 s52, s52, 3
    s_lshl_b32 s52, s52, 21
    s_lshl_b32 s53, s43, 15
    s_add_u32 s48, s52, s53
    s_add_u32 s49, s48, 16384
    s_branch L_v_go
L_v_last2:
    s_mov_b32 s20, s8
    s_mov_b32 s21, s9
    s_add_u32 s48, s43, 80
    s_lshl_b32 s48, s48, 14
    s_add_u32 s48, s48, s70
    s_mov_b32 s49, s48
L_v_go:
    s_waitcnt lgkmcnt(0)
    v_sub_f32 v40, v56, v5
    v_sub_f32 v41, v57, v5
    v_add_u32 v55, 512, v55
    v_exp_f32 v40, v40
    v_exp_f32 v41, v41
    ds_read_b32 v56, v55
    ds_read_b32 v57, v55 offset:256
    s_lshl_b32 s52, s44, 3
    s_add_u32 s52, s52, s45
    s_cmp_lg_u32 s52, 24
    s_cbranch_scc1 L_v_noprobe
    s_lshl_b32 s52, s42, 3
    s_load_dword s65, s[38:39], s52 glc
L_v_noprobe:
    v_cvt_pk_bf16_f32 v48, v40, 0
    v_cvt_pk_bf16_f32 v49, 0, v40
    v_cvt_pk_bf16_f32 v50, v41, 0
    v_cvt_pk_bf16_f32 v51, 0, v41
    v_add_f32 v6, v6, v40
    v_add_f32 v6, v6, v41
    v_dot2c_f32_bf16_dpp v16, v48, v64 row_newbcast:0 row_mask:0xf bank_mask:0xf
    v_dot2c_f32_bf16_dpp v17, v49, v64 row_newbcast:0 row_mask:0xf bank_mask:0xf
    v_dot2c_f32_bf16_dpp v18, v48, v65 row_newbcast:0 row_mask:0xf bank_mask:0xf
    v_dot2c_f32_bf16_dpp v19, v49, v65 row_newbcast:0 row_mask:0xf bank_mask:0xf
    v_dot2c_f32_bf16_dpp v20, v48, v66 row_newbcast:0 row_mask:0xf bank_mask:0xf
    v_dot2c_f32_bf16_dpp v21, v49, v66 row_newbcast:0 row_mask:0xf bank_mask:0xf
    v_dot2c_f32_bf16_dpp v22, v48, v67 row_newbcast:0 row_mask:0xf bank_mask:0xf
    v_dot2c_f32_bf16_dpp v23, v49, v67 row_newbcast:0 row_mask:0xf bank_mask:0xf
    v_dot2c_f32_bf16_dpp v16, v48, v68 row_newbcast:8 row_mask:0xf bank_mask:0xf
    v_dot2c_f32_bf16_dpp v17, v49, v68 row_newbcast:8 row_mask:0xf bank_mask:0xf
    v_dot2c_f32_bf16_dpp v18, v48, v69 row_newbcast:8 row_mask:0xf bank_mask:0xf
    v_dot2c_f32_bf16_dpp v19, v49, v69 row_newbcast:8 row_mask:0xf bank_mask:0xf
    v_dot2c_f32_bf16_dpp v20, v48, v70 row_newbcast:8 row_mask:0xf bank_mask:0xf
    v_dot2c_f32_bf16_dpp v21, v49, v70 row_newbcast:8 row_mask:0xf bank_mask:0xf
    v_dot2c_f32_bf16_dpp v22, v48, v71 row_newbcast:8 row_mask:0xf bank_mask:0xf
    v_dot2c_f32_bf16_dpp v23, v49, v71 row_newbcast:8 row_mask:0xf bank_mask:0xf
    s_waitcnt vmcnt(19)
    buffer_load_dwordx4 v[156:159], v2, s[12:15], s47 offen offset:3072 nt
    buffer_load_dwordx4 v[160:163], v3, s[12:15], s47 offen offset:0 nt
    v_dot2c_f32_bf16_dpp v16, v48, v72 row_newbcast:4 row_mask:0xf bank_mask:0xf
    v_dot2c_f32_bf16_dpp v17, v49, v72 row_newbcast:4 row_mask:0xf bank_mask:0xf
    v_dot2c_f32_bf16_dpp v18, v48, v73 row_newbcast:4 row_mask:0xf bank_mask:0xf
    v_dot2c_f32_bf16_dpp v19, v49, v73 row_newbcast:4 row_mask:0xf bank_mask:0xf
    v_dot2c_f32_bf16_dpp v20, v48, v74 row_newbcast:4 row_mask:0xf bank_mask:0xf
    v_dot2c_f32_bf16_dpp v21, v49, v74 row_newbcast:4 row_mask:0xf bank_mask:0xf
    v_dot2c_f32_bf16_dpp v22, v48, v75 row_newbcast:4 row_mask:0xf bank_mask:0xf
    v_dot2c_f32_bf16_dpp v23, v49, v75 row_newbcast:4 row_mask:0xf bank_mask:0xf
    v_dot2c_f32_bf16_dpp v16, v48, v76 row_newbcast:12 row_mask:0xf bank_mask:0xf
    v_dot2c_f32_bf16_dpp v17, v49, v76 row_newbcast:12 row_mask:0xf bank_mask:0xf
    v_dot2c_f32_bf16_dpp v18, v48, v77 row_newbcast:12 row_mask:0xf bank_mask:0xf
    v_dot2c_f32_bf16_dpp v19, v49, v77 row_newbcast:12 row_mask:0xf bank_mask:0xf
    v_dot2c_f32_bf16_dpp v20, v48, v78 row_newbcast:12 row_mask:0xf bank_mask:0xf
    v_dot2c_f32_bf16_dpp v21, v49, v78 row_newbcast:12 row_mask:0xf bank_mask:0xf
    v_dot2c_f32_bf16_dpp v22, v48, v79 row_newbcast:12 row_mask:0xf bank_mask:0xf
    v_dot2c_f32_bf16_dpp v23, v49, v79 row_newbcast:12 row_mask:0xf bank_mask:0xf
    s_waitcnt vmcnt(19)
    buffer_load_dwordx4 v[164:167], v3, s[12:15], s47 offen offset:1024 nt
    buffer_load_dwordx4 v[168:171], v3, s[12:15], s47 offen offset:2048 nt
    v_dot2c_f32_bf16_dpp v16, v48, v80 row_newbcast:2 row_mask:0xf bank_mask:0xf
    v_dot2c_f32_bf16_dpp v17, v49, v80 row_newbcast:2 row_mask:0xf bank_mask:0xf
    v_dot2c_f32_bf16_dpp v18, v48, v81 row_newbcast:2 row_mask:0xf bank_mask:0xf
    v_dot2c_f32_bf16_dpp v19, v49, v81 row_newbcast:2 row_mask:0xf bank_mask:0xf
    v_dot2c_f32_bf16_dpp v20, v48, v82 row_newbcast:2 row_mask:0xf bank_mask:0xf
    v_dot2c_f32_bf16_dpp v21, v49, v82 row_newbcast:2 row_mask:0xf bank_mask:0xf
    v_dot2c_f32_bf16_dpp v22, v48, v83 row_newbcast:2 row_mask:0xf bank_mask:0xf
    v_dot2c_f32_bf16_dpp v23, v49, v83 row_newbcast:2 row_mask:0xf bank_mask:0xf
    v_dot2c_f32_bf16_dpp v16, v48, v84 row_newbcast:10 row_mask:0xf bank_mask:0xf
    v_dot2c_f32_bf16_dpp v17, v49, v84 row_newbcast:10 row_mask:0xf bank_mask:0xf
    v_dot2c_f32_bf16_dpp v18, v48, v85 row_newbcast:10 row_mask:0xf bank_mask:0xf
    v_dot2c_f32_bf16_dpp v19, v49, v85 row_newbcast:10 row_mask:0xf bank_mask:0xf
    v_dot2c_f32_bf16_dpp v20, v48, v86 row_newbcast:10 row_mask:0xf bank_mask:0xf
    v_dot2c_f32_bf16_dpp v21, v49, v86 row_newbcast:10 row_mask:0xf bank_mask:0xf
    v_dot2c_f32_bf16_dpp v22, v48, v87 row_newbcast:10 row_mask:0xf bank_mask:0xf
    v_dot2c_f32_bf16_dpp v23, v49, v87 row_newbcast:10 row_mask:0xf bank_mask:0xf
    s_waitcnt vmcnt(19)
    buffer_load_dwordx4 v[172:175], v3, s[12:15], s47 offen offset:3072 nt
    buffer_load_dwordx4 v[176:179], v4, s[12:15], s47 offen offset:0 nt
    v_dot2c_f32_bf16_dpp v16, v48, v88 row_newbcast:6 row_mask:0xf bank_mask:0xf
    v_dot2c_f32_bf16_dpp v17, v49, v88 row_newbcast:6 row_mask:0xf bank_mask:0xf
    v_dot2c_f32_bf16_dpp v18, v48, v89 row_newbcast:6 row_mask:0xf bank_mask:0xf
    v_dot2c_f32_bf16_dpp v19, v49, v89 row_newbcast:6 row_mask:0xf bank_mask:0xf
    v_dot2c_f32_bf16_dpp v20, v48, v90 row_newbcast:6 row_mask:0xf bank_mask:0xf
    v_dot2c_f32_bf16_dpp v21, v49, v90 row_newbcast:6 row_mask:0xf bank_mask:0xf
    v_dot2c_f32_bf16_dpp v22, v48, v91 row_newbcast:6 row_mask:0xf bank_mask:0xf
    v_dot2c_f32_bf16_dpp v23, v49, v91 row_newbcast:6 row_mask:0xf bank_mask:0xf
    v_dot2c_f32_bf16_dpp v16, v48, v92 row_newbcast:14 row_mask:0xf bank_mask:0xf
    v_dot2c_f32_bf16_dpp v17, v49, v92 row_newbcast:14 row_mask:0xf bank_mask:0xf
    v_dot2c_f32_bf16_dpp v18, v48, v93 row_newbcast:14 row_mask:0xf bank_mask:0xf
    v_dot2c_f32_bf16_dpp v19, v49, v93 row_newbcast:14 row_mask:0xf bank_mask:0xf
    v_dot2c_f32_bf16_dpp v20, v48, v94 row_newbcast:14 row_mask:0xf bank_mask:0xf
    v_dot2c_f32_bf16_dpp v21, v49, v94 row_newbcast:14 row_mask:0xf bank_mask:0xf
    v_dot2c_f32_bf16_dpp v22, v48, v95 row_newbcast:14 row_mask:0xf bank_mask:0xf
    v_dot2c_f32_bf16_dpp v23, v49, v95 row_newbcast:14 row_mask:0xf bank_mask:0xf
    s_waitcnt vmcnt(19)
    buffer_load_dwordx4 v[180:183], v4, s[12:15], s47 offen offset:1024 nt
    buffer_load_dwordx4 v[184:187], v4, s[12:15], s47 offen offset:2048 nt
    v_dot2c_f32_bf16_dpp v16, v48, v96 row_newbcast:1 row_mask:0xf bank_mask:0xf
    v_dot2c_f32_bf16_dpp v17, v49, v96 row_newbcast:1 row_mask:0xf bank_mask:0xf
    v_dot2c_f32_bf16_dpp v18, v48, v97 row_newbcast:1 row_mask:0xf bank_mask:0xf
    v_dot2c_f32_bf16_dpp v19, v49, v97 row_newbcast:1 row_mask:0xf bank_mask:0xf
    v_dot2c_f32_bf16_dpp v20, v48, v98 row_newbcast:1 row_mask:0xf bank_mask:0xf
    v_dot2c_f32_bf16_dpp v21, v49, v98 row_newbcast:1 row_mask:0xf bank_mask:0xf
    v_dot2c_f32_bf16_dpp v22, v48, v99 row_newbcast:1 row_mask:0xf bank_mask:0xf
    v_dot2c_f32_bf16_dpp v23, v49, v99 row_newbcast:1 row_mask:0xf bank_mask:0xf
    v_dot2c_f32_bf16_dpp v16, v48, v100 row_newbcast:9 row_mask:0xf bank_mask:0xf
    v_dot2c_f32_bf16_dpp v17, v49, v100 row_newbcast:9 row_mask:0xf bank_mask:0xf
    v_dot2c_f32_bf16_dpp v18, v48, v101 row_newbcast:9 row_mask:0xf bank_mask:0xf
    v_dot2c_f32_bf16_dpp v19, v49, v101 row_newbcast:9 row_mask:0xf bank_mask:0xf
    v_dot2c_f32_bf16_dpp v20, v48, v102 row_newbcast:9 row_mask:0xf bank_mask:0xf
    v_dot2c_f32_bf16_dpp v21, v49, v102 row_newbcast:9 row_mask:0xf bank_mask:0xf
    v_dot2c_f32_bf16_dpp v22, v48, v103 row_newbcast:9 row_mask:0xf bank_mask:0xf
    v_dot2c_f32_bf16_dpp v23, v49, v103 row_newbcast:9 row_mask:0xf bank_mask:0xf
    s_waitcnt vmcnt(19)
    s_lshl_b32 s52, s44, 3
    s_add_u32 s52, s52, s45
    s_cmp_lg_u32 s52, 28
    s_cbranch_scc1 L_v_noclaim
    s_mov_b32 s54, 65536
L_rdy:
    s_cmp_ge_u32 s65, 8
    s_cbranch_scc1 L_rdy_ok
    s_sub_u32 s54, s54, 1
    s_cbranch_scc1 L_rdy_ok
    s_lshl_b32 s52, s42, 3
    s_mov_b32 s65, 0
    s_atomic_add s65, s[38:39], s52 glc
    s_waitcnt lgkmcnt(0)
    s_branch L_rdy
L_rdy_ok:
    s_lshl_b32 s52, s42, 8
    s_mov_b32 s71, 1
    s_atomic_add s71, s[40:41], s52 glc
L_v_noclaim:
    buffer_load_dwordx4 v[188:191], v4, s[12:15], s47 offen offset:3072 nt
    buffer_load_dwordx4 v[64:67], v1, s[16:19], s48 offen offset:0 nt
    v_dot2c_f32_bf16_dpp v16, v48, v104 row_newbcast:5 row_mask:0xf bank_mask:0xf
    v_dot2c_f32_bf16_dpp v17, v49, v104 row_newbcast:5 row_mask:0xf bank_mask:0xf
    v_dot2c_f32_bf16_dpp v18, v48, v105 row_newbcast:5 row_mask:0xf bank_mask:0xf
    v_dot2c_f32_bf16_dpp v19, v49, v105 row_newbcast:5 row_mask:0xf bank_mask:0xf
    v_dot2c_f32_bf16_dpp v20, v48, v106 row_newbcast:5 row_mask:0xf bank_mask:0xf
    v_dot2c_f32_bf16_dpp v21, v49, v106 row_newbcast:5 row_mask:0xf bank_mask:0xf
    v_dot2c_f32_bf16_dpp v22, v48, v107 row_newbcast:5 row_mask:0xf bank_mask:0xf
    v_dot2c_f32_bf16_dpp v23, v49, v107 row_newbcast:5 row_mask:0xf bank_mask:0xf
    v_dot2c_f32_bf16_dpp v16, v48, v108 row_newbcast:13 row_mask:0xf bank_mask:0xf
    v_dot2c_f32_bf16_dpp v17, v49, v108 row_newbcast:13 row_mask:0xf bank_mask:0xf
    v_dot2c_f32_bf16_dpp v18, v48, v109 row_newbcast:13 row_mask:0xf bank_mask:0xf
    v_dot2c_f32_bf16_dpp v19, v49, v109 row_newbcast:13 row_mask:0xf bank_mask:0xf
    v_dot2c_f32_bf16_dpp v20, v48, v110 row_newbcast:13 row_mask:0xf bank_mask:0xf
    v_dot2c_f32_bf16_dpp v21, v49, v110 row_newbcast:13 row_mask:0xf bank_mask:0xf
    v_dot2c_f32_bf16_dpp v22, v48, v111 row_newbcast:13 row_mask:0xf bank_mask:0xf
    v_dot2c_f32_bf16_dpp v23, v49, v111 row_newbcast:13 row_mask:0xf bank_mask:0xf
    s_waitcnt vmcnt(19)
    buffer_load_dwordx4 v[68:71], v1, s[16:19], s48 offen offset:1024 nt
    buffer_load_dwordx4 v[72:75], v1, s[16:19], s48 offen offset:2048 nt
    v_dot2c_f32_bf16_dpp v16, v48, v112 row_newbcast:3 row_mask:0xf bank_mask:0xf
    v_dot2c_f32_bf16_dpp v17, v49, v112 row_newbcast:3 row_mask:0xf bank_mask:0xf
    v_dot2c_f32_bf16_dpp v18, v48, v113 row_newbcast:3 row_mask:0xf bank_mask:0xf
    v_dot2c_f32_bf16_dpp v19, v49, v113 row_newbcast:3 row_mask:0xf bank_mask:0xf
    v_dot2c_f32_bf16_dpp v20, v48, v114 row_newbcast:3 row_mask:0xf bank_mask:0xf
    v_dot2c_f32_bf16_dpp v21, v49, v114 row_newbcast:3 row_mask:0xf bank_mask:0xf
    v_dot2c_f32_bf16_dpp v22, v48, v115 row_newbcast:3 row_mask:0xf bank_mask:0xf
    v_dot2c_f32_bf16_dpp v23, v49, v115 row_newbcast:3 row_mask:0xf bank_mask:0xf
    v_dot2c_f32_bf16_dpp v16, v48, v116 row_newbcast:11 row_mask:0xf bank_mask:0xf
    v_dot2c_f32_bf16_dpp v17, v49, v116 row_newbcast:11 row_mask:0xf bank_mask:0xf
    v_dot2c_f32_bf16_dpp v18, v48, v117 row_newbcast:11 row_mask:0xf bank_mask:0xf
    v_dot2c_f32_bf16_dpp v19, v49, v117 row_newbcast:11 row_mask:0xf bank_mask:0xf
    v_dot2c_f32_bf16_dpp v20, v48, v118 row_newbcast:11 row_mask:0xf bank_mask:0xf
    v_dot2c_f32_bf16_dpp v21, v49, v118 row_newbcast:11 row_mask:0xf bank_mask:0xf
    v_dot2c_f32_bf16_dpp v22, v48, v119 row_newbcast:11 row_mask:0xf bank_mask:0xf
    v_dot2c_f32_bf16_dpp v23, v49, v119 row_newbcast:11 row_mask:0xf bank_mask:0xf
    s_waitcnt vmcnt(19)
    buffer_load_dwordx4 v[76:79], v1, s[16:19], s48 offen offset:3072 nt
    buffer_load_dwordx4 v[80:83], v2, s[16:19], s48 offen offset:0 nt
    v_dot2c_f32_bf16_dpp v16, v48, v120 row_newbcast:7 row_mask:0xf bank_mask:0xf
    v_dot2c_f32_bf16_dpp v17, v49, v120 row_newbcast:7 row_mask:0xf bank_mask:0xf
    v_dot2c_f32_bf16_dpp v18, v48, v121 row_newbcast:7 row_mask:0xf bank_mask:0xf
    v_dot2c_f32_bf16_dpp v19, v49, v121 row_newbcast:7 row_mask:0xf bank_mask:0xf
    v_dot2c_f32_bf16_dpp v20, v48, v122 row_newbcast:7 row_mask:0xf bank_mask:0xf
    v_dot2c_f32_bf16_dpp v21, v49, v122 row_newbcast:7 row_mask:0xf bank_mask:0xf
    v_dot2c_f32_bf16_dpp v22, v48, v123 row_newbcast:7 row_mask:0xf bank_mask:0xf
    v_dot2c_f32_bf16_dpp v23, v49, v123 row_newbcast:7 row_mask:0xf bank_mask:0xf
    v_dot2c_f32_bf16_dpp v16, v48, v124 row_newbcast:15 row_mask:0xf bank_mask:0xf
    v_dot2c_f32_bf16_dpp v17, v49, v124 row_newbcast:15 row_mask:0xf bank_mask:0xf
    v_dot2c_f32_bf16_dpp v18, v48, v125 row_newbcast:15 row_mask:0xf bank_mask:0xf
    v_dot2c_f32_bf16_dpp v19, v49, v125 row_newbcast:15 row_mask:0xf bank_mask:0xf
    v_dot2c_f32_bf16_dpp v20, v48, v126 row_newbcast:15 row_mask:0xf bank_mask:0xf
    v_dot2c_f32_bf16_dpp v21, v49, v126 row_newbcast:15 row_mask:0xf bank_mask:0xf
    v_dot2c_f32_bf16_dpp v22, v48, v127 row_newbcast:15 row_mask:0xf bank_mask:0xf
    v_dot2c_f32_bf16_dpp v23, v49, v127 row_newbcast:15 row_mask:0xf bank_mask:0xf
    s_waitcnt vmcnt(19)
    buffer_load_dwordx4 v[84:87], v2, s[16:19], s48 offen offset:1024 nt
    buffer_load_dwordx4 v[88:91], v2, s[16:19], s48 offen offset:2048 nt
    v_dot2c_f32_bf16_dpp v16, v50, v128 row_newbcast:0 row_mask:0xf bank_mask:0xf
    v_dot2c_f32_bf16_dpp v17, v51, v128 row_newbcast:0 row_mask:0xf bank_mask:0xf
    v_dot2c_f32_bf16_dpp v18, v50, v129 row_newbcast:0 row_mask:0xf bank_mask:0xf
    v_dot2c_f32_bf16_dpp v19, v51, v129 row_newbcast:0 row_mask:0xf bank_mask:0xf
    v_dot2c_f32_bf16_dpp v20, v50, v130 row_newbcast:0 row_mask:0xf bank_mask:0xf
    v_dot2c_f32_bf16_dpp v21, v51, v130 row_newbcast:0 row_mask:0xf bank_mask:0xf
    v_dot2c_f32_bf16_dpp v22, v50, v131 row_newbcast:0 row_mask:0xf bank_mask:0xf
    v_dot2c_f32_bf16_dpp v23, v51, v131 row_newbcast:0 row_mask:0xf bank_mask:0xf
    v_dot2c_f32_bf16_dpp v16, v50, v132 row_newbcast:8 row_mask:0xf bank_mask:0xf
    v_dot2c_f32_bf16_dpp v17, v51, v132 row_newbcast:8 row_mask:0xf bank_mask:0xf
    v_dot2c_f32_bf16_dpp v18, v50, v133 row_newbcast:8 row_mask:0xf bank_mask:0xf
    v_dot2c_f32_bf16_dpp v19, v51, v133 row_newbcast:8 row_mask:0xf bank_mask:0xf
    v_dot2c_f32_bf16_dpp v20, v50, v134 row_newbcast:8 row_mask:0xf bank_mask:0xf
    v_dot2c_f32_bf16_dpp v21, v51, v134 row_newbcast:8 row_mask:0xf bank_mask:0xf
    v_dot2c_f32_bf16_dpp v22, v50, v135 row_newbcast:8 row_mask:0xf bank_mask:0xf
    v_dot2c_f32_bf16_dpp v23, v51, v135 row_newbcast:8 row_mask:0xf bank_mask:0xf
    s_waitcnt vmcnt(19)
    buffer_load_dwordx4 v[92:95], v2, s[16:19], s48 offen offset:3072 nt
    buffer_load_dwordx4 v[96:99], v3, s[16:19], s48 offen offset:0 nt
    v_dot2c_f32_bf16_dpp v16, v50, v136 row_newbcast:4 row_mask:0xf bank_mask:0xf
    v_dot2c_f32_bf16_dpp v17, v51, v136 row_newbcast:4 row_mask:0xf bank_mask:0xf
    v_dot2c_f32_bf16_dpp v18, v50, v137 row_newbcast:4 row_mask:0xf bank_mask:0xf
    v_dot2c_f32_bf16_dpp v19, v51, v137 row_newbcast:4 row_mask:0xf bank_mask:0xf
    v_dot2c_f32_bf16_dpp v20, v50, v138 row_newbcast:4 row_mask:0xf bank_mask:0xf
    v_dot2c_f32_bf16_dpp v21, v51, v138 row_newbcast:4 row_mask:0xf bank_mask:0xf
    v_dot2c_f32_bf16_dpp v22, v50, v139 row_newbcast:4 row_mask:0xf bank_mask:0xf
    v_dot2c_f32_bf16_dpp v23, v51, v139 row_newbcast:4 row_mask:0xf bank_mask:0xf
    v_dot2c_f32_bf16_dpp v16, v50, v140 row_newbcast:12 row_mask:0xf bank_mask:0xf
    v_dot2c_f32_bf16_dpp v17, v51, v140 row_newbcast:12 row_mask:0xf bank_mask:0xf
    v_dot2c_f32_bf16_dpp v18, v50, v141 row_newbcast:12 row_mask:0xf bank_mask:0xf
    v_dot2c_f32_bf16_dpp v19, v51, v141 row_newbcast:12 row_mask:0xf bank_mask:0xf
    v_dot2c_f32_bf16_dpp v20, v50, v142 row_newbcast:12 row_mask:0xf bank_mask:0xf
    v_dot2c_f32_bf16_dpp v21, v51, v142 row_newbcast:12 row_mask:0xf bank_mask:0xf
    v_dot2c_f32_bf16_dpp v22, v50, v143 row_newbcast:12 row_mask:0xf bank_mask:0xf
    v_dot2c_f32_bf16_dpp v23, v51, v143 row_newbcast:12 row_mask:0xf bank_mask:0xf
    s_waitcnt vmcnt(19)
    buffer_load_dwordx4 v[100:103], v3, s[16:19], s48 offen offset:1024 nt
    buffer_load_dwordx4 v[104:107], v3, s[16:19], s48 offen offset:2048 nt
    v_dot2c_f32_bf16_dpp v16, v50, v144 row_newbcast:2 row_mask:0xf bank_mask:0xf
    v_dot2c_f32_bf16_dpp v17, v51, v144 row_newbcast:2 row_mask:0xf bank_mask:0xf
    v_dot2c_f32_bf16_dpp v18, v50, v145 row_newbcast:2 row_mask:0xf bank_mask:0xf
    v_dot2c_f32_bf16_dpp v19, v51, v145 row_newbcast:2 row_mask:0xf bank_mask:0xf
    v_dot2c_f32_bf16_dpp v20, v50, v146 row_newbcast:2 row_mask:0xf bank_mask:0xf
    v_dot2c_f32_bf16_dpp v21, v51, v146 row_newbcast:2 row_mask:0xf bank_mask:0xf
    v_dot2c_f32_bf16_dpp v22, v50, v147 row_newbcast:2 row_mask:0xf bank_mask:0xf
    v_dot2c_f32_bf16_dpp v23, v51, v147 row_newbcast:2 row_mask:0xf bank_mask:0xf
    v_dot2c_f32_bf16_dpp v16, v50, v148 row_newbcast:10 row_mask:0xf bank_mask:0xf
    v_dot2c_f32_bf16_dpp v17, v51, v148 row_newbcast:10 row_mask:0xf bank_mask:0xf
    v_dot2c_f32_bf16_dpp v18, v50, v149 row_newbcast:10 row_mask:0xf bank_mask:0xf
    v_dot2c_f32_bf16_dpp v19, v51, v149 row_newbcast:10 row_mask:0xf bank_mask:0xf
    v_dot2c_f32_bf16_dpp v20, v50, v150 row_newbcast:10 row_mask:0xf bank_mask:0xf
    v_dot2c_f32_bf16_dpp v21, v51, v150 row_newbcast:10 row_mask:0xf bank_mask:0xf
    v_dot2c_f32_bf16_dpp v22, v50, v151 row_newbcast:10 row_mask:0xf bank_mask:0xf
    v_dot2c_f32_bf16_dpp v23, v51, v151 row_newbcast:10 row_mask:0xf bank_mask:0xf
    s_waitcnt vmcnt(19)
    buffer_load_dwordx4 v[108:111], v3, s[16:19], s48 offen offset:3072 nt
    buffer_load_dwordx4 v[112:115], v4, s[16:19], s48 offen offset:0 nt
    v_dot2c_f32_bf16_dpp v16, v50, v152 row_newbcast:6 row_mask:0xf bank_mask:0xf
    v_dot2c_f32_bf16_dpp v17, v51, v152 row_newbcast:6 row_mask:0xf bank_mask:0xf
    v_dot2c_f32_bf16_dpp v18, v50, v153 row_newbcast:6 row_mask:0xf bank_mask:0xf
    v_dot2c_f32_bf16_dpp v19, v51, v153 row_newbcast:6 row_mask:0xf bank_mask:0xf
    v_dot2c_f32_bf16_dpp v20, v50, v154 row_newbcast:6 row_mask:0xf bank_mask:0xf
    v_dot2c_f32_bf16_dpp v21, v51, v154 row_newbcast:6 row_mask:0xf bank_mask:0xf
    v_dot2c_f32_bf16_dpp v22, v50, v155 row_newbcast:6 row_mask:0xf bank_mask:0xf
    v_dot2c_f32_bf16_dpp v23, v51, v155 row_newbcast:6 row_mask:0xf bank_mask:0xf
    v_dot2c_f32_bf16_dpp v16, v50, v156 row_newbcast:14 row_mask:0xf bank_mask:0xf
    v_dot2c_f32_bf16_dpp v17, v51, v156 row_newbcast:14 row_mask:0xf bank_mask:0xf
    v_dot2c_f32_bf16_dpp v18, v50, v157 row_newbcast:14 row_mask:0xf bank_mask:0xf
    v_dot2c_f32_bf16_dpp v19, v51, v157 row_newbcast:14 row_mask:0xf bank_mask:0xf
    v_dot2c_f32_bf16_dpp v20, v50, v158 row_newbcast:14 row_mask:0xf bank_mask:0xf
    v_dot2c_f32_bf16_dpp v21, v51, v158 row_newbcast:14 row_mask:0xf bank_mask:0xf
    v_dot2c_f32_bf16_dpp v22, v50, v159 row_newbcast:14 row_mask:0xf bank_mask:0xf
    v_dot2c_f32_bf16_dpp v23, v51, v159 row_newbcast:14 row_mask:0xf bank_mask:0xf
    s_waitcnt vmcnt(19)
    buffer_load_dwordx4 v[116:119], v4, s[16:19], s48 offen offset:1024 nt
    buffer_load_dwordx4 v[120:123], v4, s[16:19], s48 offen offset:2048 nt
    v_dot2c_f32_bf16_dpp v16, v50, v160 row_newbcast:1 row_mask:0xf bank_mask:0xf
    v_dot2c_f32_bf16_dpp v17, v51, v160 row_newbcast:1 row_mask:0xf bank_mask:0xf
    v_dot2c_f32_bf16_dpp v18, v50, v161 row_newbcast:1 row_mask:0xf bank_mask:0xf
    v_dot2c_f32_bf16_dpp v19, v51, v161 row_newbcast:1 row_mask:0xf bank_mask:0xf
    v_dot2c_f32_bf16_dpp v20, v50, v162 row_newbcast:1 row_mask:0xf bank_mask:0xf
    v_dot2c_f32_bf16_dpp v21, v51, v162 row_newbcast:1 row_mask:0xf bank_mask:0xf
    v_dot2c_f32_bf16_dpp v22, v50, v163 row_newbcast:1 row_mask:0xf bank_mask:0xf
    v_dot2c_f32_bf16_dpp v23, v51, v163 row_newbcast:1 row_mask:0xf bank_mask:0xf
    v_dot2c_f32_bf16_dpp v16, v50, v164 row_newbcast:9 row_mask:0xf bank_mask:0xf
    v_dot2c_f32_bf16_dpp v17, v51, v164 row_newbcast:9 row_mask:0xf bank_mask:0xf
    v_dot2c_f32_bf16_dpp v18, v50, v165 row_newbcast:9 row_mask:0xf bank_mask:0xf
    v_dot2c_f32_bf16_dpp v19, v51, v165 row_newbcast:9 row_mask:0xf bank_mask:0xf
    v_dot2c_f32_bf16_dpp v20, v50, v166 row_newbcast:9 row_mask:0xf bank_mask:0xf
    v_dot2c_f32_bf16_dpp v21, v51, v166 row_newbcast:9 row_mask:0xf bank_mask:0xf
    v_dot2c_f32_bf16_dpp v22, v50, v167 row_newbcast:9 row_mask:0xf bank_mask:0xf
    v_dot2c_f32_bf16_dpp v23, v51, v167 row_newbcast:9 row_mask:0xf bank_mask:0xf
    s_waitcnt vmcnt(19)
    buffer_load_dwordx4 v[124:127], v4, s[16:19], s48 offen offset:3072 nt
    buffer_load_dwordx4 v[128:131], v1, s[20:23], s49 offen offset:0 nt
    v_dot2c_f32_bf16_dpp v16, v50, v168 row_newbcast:5 row_mask:0xf bank_mask:0xf
    v_dot2c_f32_bf16_dpp v17, v51, v168 row_newbcast:5 row_mask:0xf bank_mask:0xf
    v_dot2c_f32_bf16_dpp v18, v50, v169 row_newbcast:5 row_mask:0xf bank_mask:0xf
    v_dot2c_f32_bf16_dpp v19, v51, v169 row_newbcast:5 row_mask:0xf bank_mask:0xf
    v_dot2c_f32_bf16_dpp v20, v50, v170 row_newbcast:5 row_mask:0xf bank_mask:0xf
    v_dot2c_f32_bf16_dpp v21, v51, v170 row_newbcast:5 row_mask:0xf bank_mask:0xf
    v_dot2c_f32_bf16_dpp v22, v50, v171 row_newbcast:5 row_mask:0xf bank_mask:0xf
    v_dot2c_f32_bf16_dpp v23, v51, v171 row_newbcast:5 row_mask:0xf bank_mask:0xf
    v_dot2c_f32_bf16_dpp v16, v50, v172 row_newbcast:13 row_mask:0xf bank_mask:0xf
    v_dot2c_f32_bf16_dpp v17, v51, v172 row_newbcast:13 row_mask:0xf bank_mask:0xf
    v_dot2c_f32_bf16_dpp v18, v50, v173 row_newbcast:13 row_mask:0xf bank_mask:0xf
    v_dot2c_f32_bf16_dpp v19, v51, v173 row_newbcast:13 row_mask:0xf bank_mask:0xf
    v_dot2c_f32_bf16_dpp v20, v50, v174 row_newbcast:13 row_mask:0xf bank_mask:0xf
    v_dot2c_f32_bf16_dpp v21, v51, v174 row_newbcast:13 row_mask:0xf bank_mask:0xf
    v_dot2c_f32_bf16_dpp v22, v50, v175 row_newbcast:13 row_mask:0xf bank_mask:0xf
    v_dot2c_f32_bf16_dpp v23, v51, v175 row_newbcast:13 row_mask:0xf bank_mask:0xf
    s_waitcnt vmcnt(19)
    buffer_load_dwordx4 v[132:135], v1, s[20:23], s49 offen offset:1024 nt
    buffer_load_dwordx4 v[136:139], v1, s[20:23], s49 offen offset:2048 nt
    v_dot2c_f32_bf16_dpp v16, v50, v176 row_newbcast:3 row_mask:0xf bank_mask:0xf
    v_dot2c_f32_bf16_dpp v17, v51, v176 row_newbcast:3 row_mask:0xf bank_mask:0xf
    v_dot2c_f32_bf16_dpp v18, v50, v177 row_newbcast:3 row_mask:0xf bank_mask:0xf
    v_dot2c_f32_bf16_dpp v19, v51, v177 row_newbcast:3 row_mask:0xf bank_mask:0xf
    v_dot2c_f32_bf16_dpp v20, v50, v178 row_newbcast:3 row_mask:0xf bank_mask:0xf
    v_dot2c_f32_bf16_dpp v21, v51, v178 row_newbcast:3 row_mask:0xf bank_mask:0xf
    v_dot2c_f32_bf16_dpp v22, v50, v179 row_newbcast:3 row_mask:0xf bank_mask:0xf
    v_dot2c_f32_bf16_dpp v23, v51, v179 row_newbcast:3 row_mask:0xf bank_mask:0xf
    v_dot2c_f32_bf16_dpp v16, v50, v180 row_newbcast:11 row_mask:0xf bank_mask:0xf
    v_dot2c_f32_bf16_dpp v17, v51, v180 row_newbcast:11 row_mask:0xf bank_mask:0xf
    v_dot2c_f32_bf16_dpp v18, v50, v181 row_newbcast:11 row_mask:0xf bank_mask:0xf
    v_dot2c_f32_bf16_dpp v19, v51, v181 row_newbcast:11 row_mask:0xf bank_mask:0xf
    v_dot2c_f32_bf16_dpp v20, v50, v182 row_newbcast:11 row_mask:0xf bank_mask:0xf
    v_dot2c_f32_bf16_dpp v21, v51, v182 row_newbcast:11 row_mask:0xf bank_mask:0xf
    v_dot2c_f32_bf16_dpp v22, v50, v183 row_newbcast:11 row_mask:0xf bank_mask:0xf
    v_dot2c_f32_bf16_dpp v23, v51, v183 row_newbcast:11 row_mask:0xf bank_mask:0xf
    s_waitcnt vmcnt(19)
    buffer_load_dwordx4 v[140:143], v1, s[20:23], s49 offen offset:3072 nt
    buffer_load_dwordx4 v[144:147], v2, s[20:23], s49 offen offset:0 nt
    v_dot2c_f32_bf16_dpp v16, v50, v184 row_newbcast:7 row_mask:0xf bank_mask:0xf
    v_dot2c_f32_bf16_dpp v17, v51, v184 row_newbcast:7 row_mask:0xf bank_mask:0xf
    v_dot2c_f32_bf16_dpp v18, v50, v185 row_newbcast:7 row_mask:0xf bank_mask:0xf
    v_dot2c_f32_bf16_dpp v19, v51, v185 row_newbcast:7 row_mask:0xf bank_mask:0xf
    v_dot2c_f32_bf16_dpp v20, v50, v186 row_newbcast:7 row_mask:0xf bank_mask:0xf
    v_dot2c_f32_bf16_dpp v21, v51, v186 row_newbcast:7 row_mask:0xf bank_mask:0xf
    v_dot2c_f32_bf16_dpp v22, v50, v187 row_newbcast:7 row_mask:0xf bank_mask:0xf
    v_dot2c_f32_bf16_dpp v23, v51, v187 row_newbcast:7 row_mask:0xf bank_mask:0xf
    v_dot2c_f32_bf16_dpp v16, v50, v188 row_newbcast:15 row_mask:0xf bank_mask:0xf
    v_dot2c_f32_bf16_dpp v17, v51, v188 row_newbcast:15 row_mask:0xf bank_mask:0xf
    v_dot2c_f32_bf16_dpp v18, v50, v189 row_newbcast:15 row_mask:0xf bank_mask:0xf
    v_dot2c_f32_bf16_dpp v19, v51, v189 row_newbcast:15 row_mask:0xf bank_mask:0xf
    v_dot2c_f32_bf16_dpp v20, v50, v190 row_newbcast:15 row_mask:0xf bank_mask:0xf
    v_dot2c_f32_bf16_dpp v21, v51, v190 row_newbcast:15 row_mask:0xf bank_mask:0xf
    v_dot2c_f32_bf16_dpp v22, v50, v191 row_newbcast:15 row_mask:0xf bank_mask:0xf
    v_dot2c_f32_bf16_dpp v23, v51, v191 row_newbcast:15 row_mask:0xf bank_mask:0xf
    s_mov_b32 s12, s20
    s_mov_b32 s13, s21
    s_mov_b32 s47, s49
    s_add_u32 s45, s45, 1
    s_cmp_lg_u32 s45, s55
    s_cbranch_scc1 L_v
    s_cmp_eq_u32 s44, 3
    s_cbranch_scc1 L_kv
    s_waitcnt vmcnt(19)
    buffer_load_dwordx4 v[148:151], v2, s[12:15], s47 offen offset:1024 nt
    buffer_load_dwordx4 v[152:155], v2, s[12:15], s47 offen offset:2048 nt
    v_mov_b32 v8, v12
    v_mov_b32 v9, v13
    v_mov_b32 v10, v14
    v_mov_b32 v11, v15
    v_lshlrev_b32 v55, 2, v0
    s_add_u32 s44, s44, 1
    s_mov_b32 s45, 0
    s_add_u32 s69, s69, 1
    s_and_b32 s69, s69, 3
    s_lshl_b32 s46, s69, 21
    s_lshl_b32 s52, s43, 15
    s_add_u32 s46, s46, s52
    s_cmp_eq_u32 s44, 3
    s_cselect_b32 s55, 5, 8
    s_cbranch_scc1 L_noq
    s_add_u32 s52, s69, 1
    s_and_b32 s52, s52, 3
    s_add_u32 s52, s52, s64
    s_lshl_b32 s52, s52, 8
    v_and_b32 v41, 15, v0
    v_lshlrev_b32 v41, 4, v41
    v_add_u32 v41, s52, v41
    global_load_dwordx4 v[12:15], v41, s[24:25]
L_noq:
    s_add_u32 s52, s45, 1
    s_cmp_eq_u32 s52, s55
    s_cselect_b32 s16, s8, s4
    s_cselect_b32 s17, s9, s5
    s_cselect_b32 s53, 0, s52
    s_lshl_b32 s53, s53, 18
    s_add_u32 s48, s46, s53
    s_mov_b32 s20, s16
    s_mov_b32 s21, s17
    s_add_u32 s49, s48, 16384
    v_dot2_f32_bf16 v24, v64, v8, 0
    v_dot2_f32_bf16 v25, v68, v8, 0
    v_dot2_f32_bf16 v24, v65, v9, v24
    v_dot2_f32_bf16 v25, v69, v9, v25
    v_dot2_f32_bf16 v24, v66, v10, v24
    v_dot2_f32_bf16 v25, v70, v10, v25
    v_dot2_f32_bf16 v24, v67, v11, v24
    v_dot2_f32_bf16 v25, v71, v11, v25
    s_nop 2
    v_mov_b32 v58, v5
    v_mov_b32 v59, v5
    s_nop 1
    v_permlane32_swap_b32 v58, v59
    s_waitcnt vmcnt(19)
    buffer_load_dwordx4 v[156:159], v2, s[12:15], s47 offen offset:3072 nt
    buffer_load_dwordx4 v[160:163], v3, s[12:15], s47 offen offset:0 nt
    v_dot2_f32_bf16 v26, v72, v8, 0
    v_dot2_f32_bf16 v27, v76, v8, 0
    v_dot2_f32_bf16 v26, v73, v9, v26
    v_dot2_f32_bf16 v27, v77, v9, v27
    v_dot2_f32_bf16 v26, v74, v10, v26
    v_dot2_f32_bf16 v27, v78, v10, v27
    v_dot2_f32_bf16 v26, v75, v11, v26
    v_dot2_f32_bf16 v27, v79, v11, v27
    v_add_f32_dpp v24, v24, v24 row_ror:8 row_mask:0xf bank_mask:0x3
    v_add_f32_dpp v24, v25, v25 row_ror:8 row_mask:0xf bank_mask:0xc
    v_max_f32 v58, v58, v59
    v_mov_b32 v59, v58
    s_nop 1
    v_permlane16_swap_b32 v58, v59
    v_max_f32 v53, v58, v59
    s_waitcnt vmcnt(19)
    buffer_load_dwordx4 v[164:167], v3, s[12:15], s47 offen offset:1024 nt
    buffer_load_dwordx4 v[168:171], v3, s[12:15], s47 offen offset:2048 nt
    v_dot2_f32_bf16 v28, v80, v8, 0
    v_dot2_f32_bf16 v29, v84, v8, 0
    v_dot2_f32_bf16 v28, v81, v9, v28
    v_dot2_f32_bf16 v29, v85, v9, v29
    v_dot2_f32_bf16 v28, v82, v10, v28
    v_dot2_f32_bf16 v29, v86, v10, v29
    v_dot2_f32_bf16 v28, v83, v11, v28
    v_dot2_f32_bf16 v29, v87, v11, v29
    v_add_f32_dpp v26, v26, v26 row_ror:8 row_mask:0xf bank_mask:0x3
    v_add_f32_dpp v26, v27, v27 row_ror:8 row_mask:0xf bank_mask:0xc
    v_sub_f32 v52, v5, v53
    v_exp_f32 v52, v52
    s_nop 0
    v_mul_f32 v6, v52, v6
    v_mul_f32 v16, v52, v16
    s_waitcnt vmcnt(19)
    buffer_load_dwordx4 v[172:175], v3, s[12:15], s47 offen offset:3072 nt
    buffer_load_dwordx4 v[176:179], v4, s[12:15], s47 offen offset:0 nt
    v_dot2_f32_bf16 v30, v88, v8, 0
    v_dot2_f32_bf16 v31, v92, v8, 0
    v_dot2_f32_bf16 v30, v89, v9, v30
    v_dot2_f32_bf16 v31, v93, v9, v31
    v_dot2_f32_bf16 v30, v90, v10, v30
    v_dot2_f32_bf16 v31, v94, v10, v31
    v_dot2_f32_bf16 v30, v91, v11, v30
    v_dot2_f32_bf16 v31, v95, v11, v31
    v_add_f32_dpp v28, v28, v28 row_ror:8 row_mask:0xf bank_mask:0x3
    v_add_f32_dpp v28, v29, v29 row_ror:8 row_mask:0xf bank_mask:0xc
    v_add_f32_dpp v24, v24, v24 row_shl:4 row_mask:0xf bank_mask:0x5
    v_add_f32_dpp v24, v26, v26 row_shr:4 row_mask:0xf bank_mask:0xa
    v_mul_f32 v17, v52, v17
    v_mul_f32 v18, v52, v18
    v_mul_f32 v19, v52, v19
    v_mul_f32 v20, v52, v20
    v_mul_f32 v21, v52, v21
    s_waitcnt vmcnt(19)
    buffer_load_dwordx4 v[180:183], v4, s[12:15], s47 offen offset:1024 nt
    buffer_load_dwordx4 v[184:187], v4, s[12:15], s47 offen offset:2048 nt
    v_dot2_f32_bf16 v32, v96, v8, 0
    v_dot2_f32_bf16 v33, v100, v8, 0
    v_dot2_f32_bf16 v32, v97, v9, v32
    v_dot2_f32_bf16 v33, v101, v9, v33
    v_dot2_f32_bf16 v32, v98, v10, v32
    v_dot2_f32_bf16 v33, v102, v10, v33
    v_dot2_f32_bf16 v32, v99, v11, v32
    v_dot2_f32_bf16 v33, v103, v11, v33
    v_add_f32_dpp v30, v30, v30 row_ror:8 row_mask:0xf bank_mask:0x3
    v_add_f32_dpp v30, v31, v31 row_ror:8 row_mask:0xf bank_mask:0xc
    v_mul_f32 v22, v52, v22
    v_mul_f32 v23, v52, v23
    v_add_f32_dpp v6, v6, v6 row_ror:8 row_mask:0xf bank_mask:0xf
    v_permlane32_swap_b32 v16, v20
    v_permlane32_swap_b32 v17, v21
    s_waitcnt vmcnt(19)
    buffer_load_dwordx4 v[188:191], v4, s[12:15], s47 offen offset:3072 nt
    buffer_load_dwordx4 v[64:67], v1, s[16:19], s48 offen offset:0 nt
    v_dot2_f32_bf16 v34, v104, v8, 0
    v_dot2_f32_bf16 v35, v108, v8, 0
    v_dot2_f32_bf16 v34, v105, v9, v34
    v_dot2_f32_bf16 v35, v109, v9, v35
    v_dot2_f32_bf16 v34, v106, v10, v34
    v_dot2_f32_bf16 v35, v110, v10, v35
    v_dot2_f32_bf16 v34, v107, v11, v34
    v_dot2_f32_bf16 v35, v111, v11, v35
    v_add_f32_dpp v32, v32, v32 row_ror:8 row_mask:0xf bank_mask:0x3
    v_add_f32_dpp v32, v33, v33 row_ror:8 row_mask:0xf bank_mask:0xc
    v_add_f32_dpp v28, v28, v28 row_shl:4 row_mask:0xf bank_mask:0x5
    v_add_f32_dpp v28, v30, v30 row_shr:4 row_mask:0xf bank_mask:0xa
    v_permlane32_swap_b32 v18, v22
    v_permlane32_swap_b32 v19, v23
    v_add_f32_dpp v6, v6, v6 row_ror:4 row_mask:0xf bank_mask:0xf
    v_add_f32 v16, v16, v20
    v_add_f32 v17, v17, v21
    s_waitcnt vmcnt(19)
    buffer_load_dwordx4 v[68:71], v1, s[16:19], s48 offen offset:1024 nt
    buffer_load_dwordx4 v[72:75], v1, s[16:19], s48 offen offset:2048 nt
    v_dot2_f32_bf16 v36, v112, v8, 0
    v_dot2_f32_bf16 v37, v116, v8, 0
    v_dot2_f32_bf16 v36, v113, v9, v36
    v_dot2_f32_bf16 v37, v117, v9, v37
    v_dot2_f32_bf16 v36, v114, v10, v36
    v_dot2_f32_bf16 v37, v118, v10, v37
    v_dot2_f32_bf16 v36, v115, v11, v36
    v_dot2_f32_bf16 v37, v119, v11, v37
    v_add_f32_dpp v34, v34, v34 row_ror:8 row_mask:0xf bank_mask:0x3
    v_add_f32_dpp v34, v35, v35 row_ror:8 row_mask:0xf bank_mask:0xc
    v_add_f32_dpp v40, v24, v24 quad_perm:[2,3,0,1] row_mask:0xf bank_mask:0xf
    v_add_f32_dpp v41, v28, v28 quad_perm:[2,3,0,1] row_mask:0xf bank_mask:0xf
    v_cndmask_b32 v24, v40, v41, s[60:61]
    v_add_f32 v18, v18, v22
    v_add_f32 v19, v19, v23
    v_add_f32_dpp v6, v6, v6 row_ror:2 row_mask:0xf bank_mask:0xf
    s_nop 0
    v_permlane16_swap_b32 v16, v18
    s_waitcnt vmcnt(19)
    buffer_load_dwordx4 v[76:79], v1, s[16:19], s48 offen offset:3072 nt
    buffer_load_dwordx4 v[80:83], v2, s[16:19], s48 offen offset:0 nt
    v_dot2_f32_bf16 v38, v120, v8, 0
    v_dot2_f32_bf16 v39, v124, v8, 0
    v_dot2_f32_bf16 v38, v121, v9, v38
    v_dot2_f32_bf16 v39, v125, v9, v39
    v_dot2_f32_bf16 v38, v122, v10, v38
    v_dot2_f32_bf16 v39, v126, v10, v39
    v_dot2_f32_bf16 v38, v123, v11, v38
    v_dot2_f32_bf16 v39, v127, v11, v39
    v_add_f32_dpp v36, v36, v36 row_ror:8 row_mask:0xf bank_mask:0x3
    v_add_f32_dpp v36, v37, v37 row_ror:8 row_mask:0xf bank_mask:0xc
    v_add_f32_dpp v32, v32, v32 row_shl:4 row_mask:0xf bank_mask:0x5
    v_add_f32_dpp v32, v34, v34 row_shr:4 row_mask:0xf bank_mask:0xa
    v_add_f32_dpp v38, v38, v38 row_ror:8 row_mask:0xf bank_mask:0x3
    v_add_f32_dpp v38, v39, v39 row_ror:8 row_mask:0xf bank_mask:0xc
    v_add_f32_dpp v36, v36, v36 row_shl:4 row_mask:0xf bank_mask:0x5
    s_nop 0
    v_add_f32_dpp v36, v38, v38 row_shr:4 row_mask:0xf bank_mask:0xa
    v_add_f32_dpp v40, v32, v32 quad_perm:[2,3,0,1] row_mask:0xf bank_mask:0xf
    s_nop 0
    v_add_f32_dpp v41, v36, v36 quad_perm:[2,3,0,1] row_mask:0xf bank_mask:0xf
    v_cndmask_b32 v32, v40, v41, s[60:61]
    v_add_f32_dpp v40, v24, v24 quad_perm:[1,0,3,2] row_mask:0xf bank_mask:0xf
    s_nop 0
    v_add_f32_dpp v41, v32, v32 quad_perm:[1,0,3,2] row_mask:0xf bank_mask:0xf
    v_cndmask_b32 v40, v40, v41, s[62:63]
    v_mul_f32 v40, s50, v40
    v_max_f32 v54, v54, v40
    ds_write_b32 v55, v40 offset:0
    s_waitcnt vmcnt(19)
    buffer_load_dwordx4 v[84:87], v2, s[16:19], s48 offen offset:1024 nt
    buffer_load_dwordx4 v[88:91], v2, s[16:19], s48 offen offset:2048 nt
    v_dot2_f32_bf16 v24, v128, v8, 0
    v_dot2_f32_bf16 v25, v132, v8, 0
    v_dot2_f32_bf16 v24, v129, v9, v24
    v_dot2_f32_bf16 v25, v133, v9, v25
    v_dot2_f32_bf16 v24, v130, v10, v24
    v_dot2_f32_bf16 v25, v134, v10, v25
    v_dot2_f32_bf16 v24, v131, v11, v24
    v_dot2_f32_bf16 v25, v135, v11, v25
    v_permlane16_swap_b32 v17, v19
    v_add_f32_dpp v6, v6, v6 row_ror:1 row_mask:0xf bank_mask:0xf
    v_add_f32 v16, v16, v18
    v_add_f32 v17, v17, v19
    v_mov_b32 v58, v6
    s_waitcnt vmcnt(19)
    buffer_load_dwordx4 v[92:95], v2, s[16:19], s48 offen offset:3072 nt
    buffer_load_dwordx4 v[96:99], v3, s[16:19], s48 offen offset:0 nt
    v_dot2_f32_bf16 v26, v136, v8, 0
    v_dot2_f32_bf16 v27, v140, v8, 0
    v_dot2_f32_bf16 v26, v137, v9, v26
    v_dot2_f32_bf16 v27, v141, v9, v27
    v_dot2_f32_bf16 v26, v138, v10, v26
    v_dot2_f32_bf16 v27, v142, v10, v27
    v_dot2_f32_bf16 v26, v139, v11, v26
    v_dot2_f32_bf16 v27, v143, v11, v27
    v_add_f32_dpp v24, v24, v24 row_ror:8 row_mask:0xf bank_mask:0x3
    v_add_f32_dpp v24, v25, v25 row_ror:8 row_mask:0xf bank_mask:0xc
    s_nop 1
    v_permlane32_swap_b32 v58, v6
    v_add_f32 v6, v58, v6
    v_mov_b32 v58, v6
    s_nop 1
    s_waitcnt vmcnt(19)
    buffer_load_dwordx4 v[100:103], v3, s[16:19], s48 offen offset:1024 nt
    buffer_load_dwordx4 v[104:107], v3, s[16:19], s48 offen offset:2048 nt
    v_dot2_f32_bf16 v28, v144, v8, 0
    v_dot2_f32_bf16 v29, v148, v8, 0
    v_dot2_f32_bf16 v28, v145, v9, v28
    v_dot2_f32_bf16 v29, v149, v9, v29
    v_dot2_f32_bf16 v28, v146, v10, v28
    v_dot2_f32_bf16 v29, v150, v10, v29
    v_dot2_f32_bf16 v28, v147, v11, v28
    v_dot2_f32_bf16 v29, v151, v11, v29
    v_add_f32_dpp v26, v26, v26 row_ror:8 row_mask:0xf bank_mask:0x3
    v_add_f32_dpp v26, v27, v27 row_ror:8 row_mask:0xf bank_mask:0xc
    v_permlane16_swap_b32 v58, v6
    v_add_f32 v19, v58, v6
    v_mov_b32 v18, v53
    v_mov_b32 v240, v244
    v_mov_b32 v241, v245
    s_waitcnt vmcnt(19)
    buffer_load_dwordx4 v[108:111], v3, s[16:19], s48 offen offset:3072 nt
    buffer_load_dwordx4 v[112:115], v4, s[16:19], s48 offen offset:0 nt
    v_dot2_f32_bf16 v30, v152, v8, 0
    v_dot2_f32_bf16 v31, v156, v8, 0
    v_dot2_f32_bf16 v30, v153, v9, v30
    v_dot2_f32_bf16 v31, v157, v9, v31
    v_dot2_f32_bf16 v30, v154, v10, v30
    v_dot2_f32_bf16 v31, v158, v10, v31
    v_dot2_f32_bf16 v30, v155, v11, v30
    v_dot2_f32_bf16 v31, v159, v11, v31
    v_add_f32_dpp v28, v28, v28 row_ror:8 row_mask:0xf bank_mask:0x3
    v_add_f32_dpp v28, v29, v29 row_ror:8 row_mask:0xf bank_mask:0xc
    v_add_f32_dpp v24, v24, v24 row_shl:4 row_mask:0xf bank_mask:0x5
    v_add_f32_dpp v24, v26, v26 row_shr:4 row_mask:0xf bank_mask:0xa
    v_mov_b32 v242, v246
    v_mov_b32 v243, v247
    v_mov_b32 v244, v248
    v_mov_b32 v245, v249
    v_mov_b32 v246, v250
    s_waitcnt vmcnt(19)
    buffer_load_dwordx4 v[116:119], v4, s[16:19], s48 offen offset:1024 nt
    buffer_load_dwordx4 v[120:123], v4, s[16:19], s48 offen offset:2048 nt
    v_dot2_f32_bf16 v32, v160, v8, 0
    v_dot2_f32_bf16 v33, v164, v8, 0
    v_dot2_f32_bf16 v32, v161, v9, v32
    v_dot2_f32_bf16 v33, v165, v9, v33
    v_dot2_f32_bf16 v32, v162, v10, v32
    v_dot2_f32_bf16 v33, v166, v10, v33
    v_dot2_f32_bf16 v32, v163, v11, v32
    v_dot2_f32_bf16 v33, v167, v11, v33
    v_add_f32_dpp v30, v30, v30 row_ror:8 row_mask:0xf bank_mask:0x3
    v_add_f32_dpp v30, v31, v31 row_ror:8 row_mask:0xf bank_mask:0xc
    v_mov_b32 v247, v251
    v_mov_b32 v248, v16
    v_mov_b32 v249, v17
    v_mov_b32 v250, v18
    v_mov_b32 v251, v19
    s_waitcnt vmcnt(19)
    buffer_load_dwordx4 v[124:127], v4, s[16:19], s48 offen offset:3072 nt
    buffer_load_dwordx4 v[128:131], v1, s[20:23], s49 offen offset:0 nt
    v_dot2_f32_bf16 v34, v168, v8, 0
    v_dot2_f32_bf16 v35, v172, v8, 0
    v_dot2_f32_bf16 v34, v169, v9, v34
    v_dot2_f32_bf16 v35, v173, v9, v35
    v_dot2_f32_bf16 v34, v170, v10, v34
    v_dot2_f32_bf16 v35, v174, v10, v35
    v_dot2_f32_bf16 v34, v171, v11, v34
    v_dot2_f32_bf16 v35, v175, v11, v35
    v_add_f32_dpp v32, v32, v32 row_ror:8 row_mask:0xf bank_mask:0x3
    v_add_f32_dpp v32, v33, v33 row_ror:8 row_mask:0xf bank_mask:0xc
    v_add_f32_dpp v28, v28, v28 row_shl:4 row_mask:0xf bank_mask:0x5
    v_add_f32_dpp v28, v30, v30 row_shr:4 row_mask:0xf bank_mask:0xa
    v_mov_b32 v6, 0
    v_mov_b32 v16, 0
    v_mov_b32 v17, 0
    v_mov_b32 v18, 0
    v_mov_b32 v19, 0
    s_waitcnt vmcnt(19)
    buffer_load_dwordx4 v[132:135], v1, s[20:23], s49 offen offset:1024 nt
    buffer_load_dwordx4 v[136:139], v1, s[20:23], s49 offen offset:2048 nt
    v_dot2_f32_bf16 v36, v176, v8, 0
    v_dot2_f32_bf16 v37, v180, v8, 0
    v_dot2_f32_bf16 v36, v177, v9, v36
    v_dot2_f32_bf16 v37, v181, v9, v37
    v_dot2_f32_bf16 v36, v178, v10, v36
    v_dot2_f32_bf16 v37, v182, v10, v37
    v_dot2_f32_bf16 v36, v179, v11, v36
    v_dot2_f32_bf16 v37, v183, v11, v37
    v_add_f32_dpp v34, v34, v34 row_ror:8 row_mask:0xf bank_mask:0x3
    v_add_f32_dpp v34, v35, v35 row_ror:8 row_mask:0xf bank_mask:0xc
    v_add_f32_dpp v40, v24, v24 quad_perm:[2,3,0,1] row_mask:0xf bank_mask:0xf
    v_add_f32_dpp v41, v28, v28 quad_perm:[2,3,0,1] row_mask:0xf bank_mask:0xf
    v_cndmask_b32 v24, v40, v41, s[60:61]
    v_mov_b32 v20, 0
    v_mov_b32 v21, 0
    v_mov_b32 v22, 0
    v_mov_b32 v23, 0
    s_waitcnt vmcnt(19)
    buffer_load_dwordx4 v[140:143], v1, s[20:23], s49 offen offset:3072 nt
    buffer_load_dwordx4 v[144:147], v2, s[20:23], s49 offen offset:0 nt
    v_dot2_f32_bf16 v38, v184, v8, 0
    v_dot2_f32_bf16 v39, v188, v8, 0
    v_dot2_f32_bf16 v38, v185, v9, v38
    v_dot2_f32_bf16 v39, v189, v9, v39
    v_dot2_f32_bf16 v38, v186, v10, v38
    v_dot2_f32_bf16 v39, v190, v10, v39
    v_dot2_f32_bf16 v38, v187, v11, v38
    v_dot2_f32_bf16 v39, v191, v11, v39
    v_add_f32_dpp v36, v36, v36 row_ror:8 row_mask:0xf bank_mask:0x3
    v_add_f32_dpp v36, v37, v37 row_ror:8 row_mask:0xf bank_mask:0xc
    v_add_f32_dpp v32, v32, v32 row_shl:4 row_mask:0xf bank_mask:0x5
    v_add_f32_dpp v32, v34, v34 row_shr:4 row_mask:0xf bank_mask:0xa
    v_add_f32_dpp v38, v38, v38 row_ror:8 row_mask:0xf bank_mask:0x3
    v_add_f32_dpp v38, v39, v39 row_ror:8 row_mask:0xf bank_mask:0xc
    v_add_f32_dpp v36, v36, v36 row_shl:4 row_mask:0xf bank_mask:0x5
    s_nop 0
    v_add_f32_dpp v36, v38, v38 row_shr:4 row_mask:0xf bank_mask:0xa
    v_add_f32_dpp v40, v32, v32 quad_perm:[2,3,0,1] row_mask:0xf bank_mask:0xf
    s_nop 0
    v_add_f32_dpp v41, v36, v36 quad_perm:[2,3,0,1] row_mask:0xf bank_mask:0xf
    v_cndmask_b32 v32, v40, v41, s[60:61]
    v_add_f32_dpp v40, v24, v24 quad_perm:[1,0,3,2] row_mask:0xf bank_mask:0xf
    s_nop 0
    v_add_f32_dpp v41, v32, v32 quad_perm:[1,0,3,2] row_mask:0xf bank_mask:0xf
    v_cndmask_b32 v40, v40, v41, s[62:63]
    v_mul_f32 v40, s50, v40
    v_max_f32 v54, v54, v40
    ds_write_b32 v55, v40 offset:256
    v_add_u32 v55, 512, v55
    s_mov_b32 s12, s20
    s_mov_b32 s13, s21
    s_mov_b32 s47, s49
    s_add_u32 s45, s45, 1
    s_branch L_k
    .p2align 6
L_kv:
    s_waitcnt vmcnt(19)
    buffer_load_dwordx4 v[148:151], v2, s[12:15], s47 offen offset:1024 nt
    buffer_load_dwordx4 v[152:155], v2, s[12:15], s47 offen offset:2048 nt
    v_dot2_f32_bf16 v24, v64, v8, 0
    v_dot2_f32_bf16 v25, v68, v8, 0
    v_dot2_f32_bf16 v24, v65, v9, v24
    v_dot2_f32_bf16 v25, v69, v9, v25
    v_dot2_f32_bf16 v24, v66, v10, v24
    v_dot2_f32_bf16 v25, v70, v10, v25
    v_dot2_f32_bf16 v24, v67, v11, v24
    v_dot2_f32_bf16 v25, v71, v11, v25
    s_waitcnt vmcnt(19)
    buffer_load_dwordx4 v[156:159], v2, s[12:15], s47 offen offset:3072 nt
    buffer_load_dwordx4 v[160:163], v3, s[12:15], s47 offen offset:0 nt
    v_dot2_f32_bf16 v26, v72, v8, 0
    v_dot2_f32_bf16 v27, v76, v8, 0
    v_dot2_f32_bf16 v26, v73, v9, v26
    v_dot2_f32_bf16 v27, v77, v9, v27
    v_dot2_f32_bf16 v26, v74, v10, v26
    v_dot2_f32_bf16 v27, v78, v10, v27
    v_dot2_f32_bf16 v26, v75, v11, v26
    v_dot2_f32_bf16 v27, v79, v11, v27
    v_add_f32_dpp v24, v24, v24 row_ror:8 row_mask:0xf bank_mask:0x3
    v_add_f32_dpp v24, v25, v25 row_ror:8 row_mask:0xf bank_mask:0xc
    s_waitcnt vmcnt(19)
    buffer_load_dwordx4 v[164:167], v3, s[12:15], s47 offen offset:1024 nt
    buffer_load_dwordx4 v[168:171], v3, s[12:15], s47 offen offset:2048 nt
    v_dot2_f32_bf16 v28, v80, v8, 0
    v_dot2_f32_bf16 v29, v84, v8, 0
    v_dot2_f32_bf16 v28, v81, v9, v28
    v_dot2_f32_bf16 v29, v85, v9, v29
    v_dot2_f32_bf16 v28, v82, v10, v28
    v_dot2_f32_bf16 v29, v86, v10, v29
    v_dot2_f32_bf16 v28, v83, v11, v28
    v_dot2_f32_bf16 v29, v87, v11, v29
    v_add_f32_dpp v26, v26, v26 row_ror:8 row_mask:0xf bank_mask:0x3
    v_add_f32_dpp v26, v27, v27 row_ror:8 row_mask:0xf bank_mask:0xc
    s_waitcnt vmcnt(19)
    buffer_load_dwordx4 v[172:175], v3, s[12:15], s47 offen offset:3072 nt
    buffer_load_dwordx4 v[176:179], v4, s[12:15], s47 offen offset:0 nt
    v_dot2_f32_bf16 v30, v88, v8, 0
    v_dot2_f32_bf16 v31, v92, v8, 0
    v_dot2_f32_bf16 v30, v89, v9, v30
    v_dot2_f32_bf16 v31, v93, v9, v31
    v_dot2_f32_bf16 v30, v90, v10, v30
    v_dot2_f32_bf16 v31, v94, v10, v31
    v_dot2_f32_bf16 v30, v91, v11, v30
    v_dot2_f32_bf16 v31, v95, v11, v31
    v_add_f32_dpp v28, v28, v28 row_ror:8 row_mask:0xf bank_mask:0x3
    v_add_f32_dpp v28, v29, v29 row_ror:8 row_mask:0xf bank_mask:0xc
    v_add_f32_dpp v24, v24, v24 row_shl:4 row_mask:0xf bank_mask:0x5
    v_add_f32_dpp v24, v26, v26 row_shr:4 row_mask:0xf bank_mask:0xa
    s_waitcnt vmcnt(19)
    buffer_load_dwordx4 v[180:183], v4, s[12:15], s47 offen offset:1024 nt
    buffer_load_dwordx4 v[184:187], v4, s[12:15], s47 offen offset:2048 nt
    v_dot2_f32_bf16 v32, v96, v8, 0
    v_dot2_f32_bf16 v33, v100, v8, 0
    v_dot2_f32_bf16 v32, v97, v9, v32
    v_dot2_f32_bf16 v33, v101, v9, v33
    v_dot2_f32_bf16 v32, v98, v10, v32
    v_dot2_f32_bf16 v33, v102, v10, v33
    v_dot2_f32_bf16 v32, v99, v11, v32
    v_dot2_f32_bf16 v33, v103, v11, v33
    v_add_f32_dpp v30, v30, v30 row_ror:8 row_mask:0xf bank_mask:0x3
    v_add_f32_dpp v30, v31, v31 row_ror:8 row_mask:0xf bank_mask:0xc
    s_waitcnt vmcnt(19)
    s_waitcnt lgkmcnt(0)
    s_mov_b32 s57, s71
    s_cmp_ge_u32 s57, 40
    s_cbranch_scc1 L_final
    s_add_u32 s48, s57, 88
    s_lshl_b32 s48, s48, 14
    s_add_u32 s48, s48, s70
    s_mov_b32 s49, s48
    s_lshl_b32 s52, s42, 8
    s_mov_b32 s71, 1
    s_atomic_add s71, s[40:41], s52 glc
    buffer_load_dwordx4 v[188:191], v4, s[12:15], s47 offen offset:3072 nt
    buffer_load_dwordx4 v[64:67], v1, s[16:19], s48 offen offset:0 nt
    v_dot2_f32_bf16 v34, v104, v8, 0
    v_dot2_f32_bf16 v35, v108, v8, 0
    v_dot2_f32_bf16 v34, v105, v9, v34
    v_dot2_f32_bf16 v35, v109, v9, v35
    v_dot2_f32_bf16 v34, v106, v10, v34
    v_dot2_f32_bf16 v35, v110, v10, v35
    v_dot2_f32_bf16 v34, v107, v11, v34
    v_dot2_f32_bf16 v35, v111, v11, v35
    v_add_f32_dpp v32, v32, v32 row_ror:8 row_mask:0xf bank_mask:0x3
    v_add_f32_dpp v32, v33, v33 row_ror:8 row_mask:0xf bank_mask:0xc
    v_add_f32_dpp v28, v28, v28 row_shl:4 row_mask:0xf bank_mask:0x5
    v_add_f32_dpp v28, v30, v30 row_shr:4 row_mask:0xf bank_mask:0xa
    s_waitcnt vmcnt(19)
    buffer_load_dwordx4 v[68:71], v1, s[16:19], s48 offen offset:1024 nt
    buffer_load_dwordx4 v[72:75], v1, s[16:19], s48 offen offset:2048 nt
    v_dot2_f32_bf16 v36, v112, v8, 0
    v_dot2_f32_bf16 v37, v116, v8, 0
    v_dot2_f32_bf16 v36, v113, v9, v36
    v_dot2_f32_bf16 v37, v117, v9, v37
    v_dot2_f32_bf16 v36, v114, v10, v36
    v_dot2_f32_bf16 v37, v118, v10, v37
    v_dot2_f32_bf16 v36, v115, v11, v36
    v_dot2_f32_bf16 v37, v119, v11, v37
    v_add_f32_dpp v34, v34, v34 row_ror:8 row_mask:0xf bank_mask:0x3
    v_add_f32_dpp v34, v35, v35 row_ror:8 row_mask:0xf bank_mask:0xc
    v_add_f32_dpp v40, v24, v24 quad_perm:[2,3,0,1] row_mask:0xf bank_mask:0xf
    v_add_f32_dpp v41, v28, v28 quad_perm:[2,3,0,1] row_mask:0xf bank_mask:0xf
    v_cndmask_b32 v24, v40, v41, s[60:61]
    s_waitcnt vmcnt(19)
    buffer_load_dwordx4 v[76:79], v1, s[16:19], s48 offen offset:3072 nt
    buffer_load_dwordx4 v[80:83], v2, s[16:19], s48 offen offset:0 nt
    v_dot2_f32_bf16 v38, v120, v8, 0
    v_dot2_f32_bf16 v39, v124, v8, 0
    v_dot2_f32_bf16 v38, v121, v9, v38
    v_dot2_f32_bf16 v39, v125, v9, v39
    v_dot2_f32_bf16 v38, v122, v10, v38
    v_dot2_f32_bf16 v39, v126, v10, v39
    v_dot2_f32_bf16 v38, v123, v11, v38
    v_dot2_f32_bf16 v39, v127, v11, v39
    v_add_f32_dpp v36, v36, v36 row_ror:8 row_mask:0xf bank_mask:0x3
    v_add_f32_dpp v36, v37, v37 row_ror:8 row_mask:0xf bank_mask:0xc
    v_add_f32_dpp v32, v32, v32 row_shl:4 row_mask:0xf bank_mask:0x5
    v_add_f32_dpp v32, v34, v34 row_shr:4 row_mask:0xf bank_mask:0xa
    v_add_f32_dpp v38, v38, v38 row_ror:8 row_mask:0xf bank_mask:0x3
    v_add_f32_dpp v38, v39, v39 row_ror:8 row_mask:0xf bank_mask:0xc
    v_add_f32_dpp v36, v36, v36 row_shl:4 row_mask:0xf bank_mask:0x5
    s_nop 0
    v_add_f32_dpp v36, v38, v38 row_shr:4 row_mask:0xf bank_mask:0xa
    v_add_f32_dpp v40, v32, v32 quad_perm:[2,3,0,1] row_mask:0xf bank_mask:0xf
    s_nop 0
    v_add_f32_dpp v41, v36, v36 quad_perm:[2,3,0,1] row_mask:0xf bank_mask:0xf
    v_cndmask_b32 v32, v40, v41, s[60:61]
    v_add_f32_dpp v40, v24, v24 quad_perm:[1,0,3,2] row_mask:0xf bank_mask:0xf
    s_nop 0
    v_add_f32_dpp v41, v32, v32 quad_perm:[1,0,3,2] row_mask:0xf bank_mask:0xf
    v_cndmask_b32 v40, v40, v41, s[62:63]
    v_mul_f32 v40, s50, v40
    s_nop 1
    v_max_f32_dpp v41, v40, v40 row_ror:8 row_mask:0xf bank_mask:0xf
    s_nop 1
    v_max_f32_dpp v41, v41, v41 row_ror:4 row_mask:0xf bank_mask:0xf
    s_nop 1
    v_max_f32_dpp v41, v41, v41 row_ror:2 row_mask:0xf bank_mask:0xf
    s_nop 1
    v_max_f32_dpp v41, v41, v41 row_ror:1 row_mask:0xf bank_mask:0xf
    buffer_load_dwordx4 v[84:87], v2, s[16:19], s48 offen offset:1024 nt
    buffer_load_dwordx4 v[88:91], v2, s[16:19], s48 offen offset:2048 nt
    buffer_load_dwordx4 v[92:95], v2, s[16:19], s48 offen offset:3072 nt
    buffer_load_dwordx4 v[96:99], v3, s[16:19], s48 offen offset:0 nt
    v_max_f32 v53, v5, v41
    v_sub_f32 v52, v5, v53
    v_sub_f32 v40, v40, v53
    v_exp_f32 v52, v52
    v_exp_f32 v40, v40
    v_mov_b32 v5, v53
    v_cvt_pk_bf16_f32 v48, v40, 0
    v_cvt_pk_bf16_f32 v49, 0, v40
    v_fma_f32 v6, v6, v52, v40
    v_mul_f32 v16, v52, v16
    v_mul_f32 v17, v52, v17
    v_mul_f32 v18, v52, v18
    v_mul_f32 v19, v52, v19
    v_mul_f32 v20, v52, v20
    v_mul_f32 v21, v52, v21
    v_mul_f32 v22, v52, v22
    v_mul_f32 v23, v52, v23
    s_waitcnt vmcnt(23)
    v_dot2c_f32_bf16_dpp v16, v48, v128 row_newbcast:0 row_mask:0xf bank_mask:0xf
    v_dot2c_f32_bf16_dpp v17, v49, v128 row_newbcast:0 row_mask:0xf bank_mask:0xf
    v_dot2c_f32_bf16_dpp v18, v48, v129 row_newbcast:0 row_mask:0xf bank_mask:0xf
    v_dot2c_f32_bf16_dpp v19, v49, v129 row_newbcast:0 row_mask:0xf bank_mask:0xf
    v_dot2c_f32_bf16_dpp v20, v48, v130 row_newbcast:0 row_mask:0xf bank_mask:0xf
    v_dot2c_f32_bf16_dpp v21, v49, v130 row_newbcast:0 row_mask:0xf bank_mask:0xf
    v_dot2c_f32_bf16_dpp v22, v48, v131 row_newbcast:0 row_mask:0xf bank_mask:0xf
    v_dot2c_f32_bf16_dpp v23, v49, v131 row_newbcast:0 row_mask:0xf bank_mask:0xf
    v_dot2c_f32_bf16_dpp v16, v48, v132 row_newbcast:8 row_mask:0xf bank_mask:0xf
    v_dot2c_f32_bf16_dpp v17, v49, v132 row_newbcast:8 row_mask:0xf bank_mask:0xf
    v_dot2c_f32_bf16_dpp v18, v48, v133 row_newbcast:8 row_mask:0xf bank_mask:0xf
    v_dot2c_f32_bf16_dpp v19, v49, v133 row_newbcast:8 row_mask:0xf bank_mask:0xf
    v_dot2c_f32_bf16_dpp v20, v48, v134 row_newbcast:8 row_mask:0xf bank_mask:0xf
    v_dot2c_f32_bf16_dpp v21, v49, v134 row_newbcast:8 row_mask:0xf bank_mask:0xf
    v_dot2c_f32_bf16_dpp v22, v48, v135 row_newbcast:8 row_mask:0xf bank_mask:0xf
    v_dot2c_f32_bf16_dpp v23, v49, v135 row_newbcast:8 row_mask:0xf bank_mask:0xf
    s_waitcnt vmcnt(21)
    v_dot2c_f32_bf16_dpp v16, v48, v136 row_newbcast:4 row_mask:0xf bank_mask:0xf
    v_dot2c_f32_bf16_dpp v17, v49, v136 row_newbcast:4 row_mask:0xf bank_mask:0xf
    v_dot2c_f32_bf16_dpp v18, v48, v137 row_newbcast:4 row_mask:0xf bank_mask:0xf
    v_dot2c_f32_bf16_dpp v19, v49, v137 row_newbcast:4 row_mask:0xf bank_mask:0xf
    v_dot2c_f32_bf16_dpp v20, v48, v138 row_newbcast:4 row_mask:0xf bank_mask:0xf
    v_dot2c_f32_bf16_dpp v21, v49, v138 row_newbcast:4 row_mask:0xf bank_mask:0xf
    v_dot2c_f32_bf16_dpp v22, v48, v139 row_newbcast:4 row_mask:0xf bank_mask:0xf
    v_dot2c_f32_bf16_dpp v23, v49, v139 row_newbcast:4 row_mask:0xf bank_mask:0xf
    v_dot2c_f32_bf16_dpp v16, v48, v140 row_newbcast:12 row_mask:0xf bank_mask:0xf
    v_dot2c_f32_bf16_dpp v17, v49, v140 row_newbcast:12 row_mask:0xf bank_mask:0xf
    v_dot2c_f32_bf16_dpp v18, v48, v141 row_newbcast:12 row_mask:0xf bank_mask:0xf
    v_dot2c_f32_bf16_dpp v19, v49, v141 row_newbcast:12 row_mask:0xf bank_mask:0xf
    v_dot2c_f32_bf16_dpp v20, v48, v142 row_newbcast:12 row_mask:0xf bank_mask:0xf
    v_dot2c_f32_bf16_dpp v21, v49, v142 row_newbcast:12 row_mask:0xf bank_mask:0xf
    v_dot2c_f32_bf16_dpp v22, v48, v143 row_newbcast:12 row_mask:0xf bank_mask:0xf
    v_dot2c_f32_bf16_dpp v23, v49, v143 row_newbcast:12 row_mask:0xf bank_mask:0xf
    s_waitcnt vmcnt(19)
    buffer_load_dwordx4 v[100:103], v3, s[16:19], s48 offen offset:1024 nt
    buffer_load_dwordx4 v[104:107], v3, s[16:19], s48 offen offset:2048 nt
    v_dot2c_f32_bf16_dpp v16, v48, v144 row_newbcast:2 row_mask:0xf bank_mask:0xf
    v_dot2c_f32_bf16_dpp v17, v49, v144 row_newbcast:2 row_mask:0xf bank_mask:0xf
    v_dot2c_f32_bf16_dpp v18, v48, v145 row_newbcast:2 row_mask:0xf bank_mask:0xf
    v_dot2c_f32_bf16_dpp v19, v49, v145 row_newbcast:2 row_mask:0xf bank_mask:0xf
    v_dot2c_f32_bf16_dpp v20, v48, v146 row_newbcast:2 row_mask:0xf bank_mask:0xf
    v_dot2c_f32_bf16_dpp v21, v49, v146 row_newbcast:2 row_mask:0xf bank_mask:0xf
    v_dot2c_f32_bf16_dpp v22, v48, v147 row_newbcast:2 row_mask:0xf bank_mask:0xf
    v_dot2c_f32_bf16_dpp v23, v49, v147 row_newbcast:2 row_mask:0xf bank_mask:0xf
    v_dot2c_f32_bf16_dpp v16, v48, v148 row_newbcast:10 row_mask:0xf bank_mask:0xf
    v_dot2c_f32_bf16_dpp v17, v49, v148 row_newbcast:10 row_mask:0xf bank_mask:0xf
    v_dot2c_f32_bf16_dpp v18, v48, v149 row_newbcast:10 row_mask:0xf bank_mask:0xf
    v_dot2c_f32_bf16_dpp v19, v49, v149 row_newbcast:10 row_mask:0xf bank_mask:0xf
    v_dot2c_f32_bf16_dpp v20, v48, v150 row_newbcast:10 row_mask:0xf bank_mask:0xf
    v_dot2c_f32_bf16_dpp v21, v49, v150 row_newbcast:10 row_mask:0xf bank_mask:0xf
    v_dot2c_f32_bf16_dpp v22, v48, v151 row_newbcast:10 row_mask:0xf bank_mask:0xf
    v_dot2c_f32_bf16_dpp v23, v49, v151 row_newbcast:10 row_mask:0xf bank_mask:0xf
    s_waitcnt vmcnt(19)
    buffer_load_dwordx4 v[108:111], v3, s[16:19], s48 offen offset:3072 nt
    buffer_load_dwordx4 v[112:115], v4, s[16:19], s48 offen offset:0 nt
    v_dot2c_f32_bf16_dpp v16, v48, v152 row_newbcast:6 row_mask:0xf bank_mask:0xf
    v_dot2c_f32_bf16_dpp v17, v49, v152 row_newbcast:6 row_mask:0xf bank_mask:0xf
    v_dot2c_f32_bf16_dpp v18, v48, v153 row_newbcast:6 row_mask:0xf bank_mask:0xf
    v_dot2c_f32_bf16_dpp v19, v49, v153 row_newbcast:6 row_mask:0xf bank_mask:0xf
    v_dot2c_f32_bf16_dpp v20, v48, v154 row_newbcast:6 row_mask:0xf bank_mask:0xf
    v_dot2c_f32_bf16_dpp v21, v49, v154 row_newbcast:6 row_mask:0xf bank_mask:0xf
    v_dot2c_f32_bf16_dpp v22, v48, v155 row_newbcast:6 row_mask:0xf bank_mask:0xf
    v_dot2c_f32_bf16_dpp v23, v49, v155 row_newbcast:6 row_mask:0xf bank_mask:0xf
    v_dot2c_f32_bf16_dpp v16, v48, v156 row_newbcast:14 row_mask:0xf bank_mask:0xf
    v_dot2c_f32_bf16_dpp v17, v49, v156 row_newbcast:14 row_mask:0xf bank_mask:0xf
    v_dot2c_f32_bf16_dpp v18, v48, v157 row_newbcast:14 row_mask:0xf bank_mask:0xf
    v_dot2c_f32_bf16_dpp v19, v49, v157 row_newbcast:14 row_mask:0xf bank_mask:0xf
    v_dot2c_f32_bf16_dpp v20, v48, v158 row_newbcast:14 row_mask:0xf bank_mask:0xf
    v_dot2c_f32_bf16_dpp v21, v49, v158 row_newbcast:14 row_mask:0xf bank_mask:0xf
    v_dot2c_f32_bf16_dpp v22, v48, v159 row_newbcast:14 row_mask:0xf bank_mask:0xf
    v_dot2c_f32_bf16_dpp v23, v49, v159 row_newbcast:14 row_mask:0xf bank_mask:0xf
    s_waitcnt vmcnt(19)
    buffer_load_dwordx4 v[116:119], v4, s[16:19], s48 offen offset:1024 nt
    buffer_load_dwordx4 v[120:123], v4, s[16:19], s48 offen offset:2048 nt
    v_dot2c_f32_bf16_dpp v16, v48, v160 row_newbcast:1 row_mask:0xf bank_mask:0xf
    v_dot2c_f32_bf16_dpp v17, v49, v160 row_newbcast:1 row_mask:0xf bank_mask:0xf
    v_dot2c_f32_bf16_dpp v18, v48, v161 row_newbcast:1 row_mask:0xf bank_mask:0xf
    v_dot2c_f32_bf16_dpp v19, v49, v161 row_newbcast:1 row_mask:0xf bank_mask:0xf
    v_dot2c_f32_bf16_dpp v20, v48, v162 row_newbcast:1 row_mask:0xf bank_mask:0xf
    v_dot2c_f32_bf16_dpp v21, v49, v162 row_newbcast:1 row_mask:0xf bank_mask:0xf
    v_dot2c_f32_bf16_dpp v22, v48, v163 row_newbcast:1 row_mask:0xf bank_mask:0xf
    v_dot2c_f32_bf16_dpp v23, v49, v163 row_newbcast:1 row_mask:0xf bank_mask:0xf
    v_dot2c_f32_bf16_dpp v16, v48, v164 row_newbcast:9 row_mask:0xf bank_mask:0xf
    v_dot2c_f32_bf16_dpp v17, v49, v164 row_newbcast:9 row_mask:0xf bank_mask:0xf
    v_dot2c_f32_bf16_dpp v18, v48, v165 row_newbcast:9 row_mask:0xf bank_mask:0xf
    v_dot2c_f32_bf16_dpp v19, v49, v165 row_newbcast:9 row_mask:0xf bank_mask:0xf
    v_dot2c_f32_bf16_dpp v20, v48, v166 row_newbcast:9 row_mask:0xf bank_mask:0xf
    v_dot2c_f32_bf16_dpp v21, v49, v166 row_newbcast:9 row_mask:0xf bank_mask:0xf
    v_dot2c_f32_bf16_dpp v22, v48, v167 row_newbcast:9 row_mask:0xf bank_mask:0xf
    v_dot2c_f32_bf16_dpp v23, v49, v167 row_newbcast:9 row_mask:0xf bank_mask:0xf
    s_waitcnt vmcnt(19)
    buffer_load_dwordx4 v[124:127], v4, s[16:19], s48 offen offset:3072 nt
    buffer_load_dwordx4 v[128:131], v1, s[20:23], s49 offen offset:0 nt
    v_dot2c_f32_bf16_dpp v16, v48, v168 row_newbcast:5 row_mask:0xf bank_mask:0xf
    v_dot2c_f32_bf16_dpp v17, v49, v168 row_newbcast:5 row_mask:0xf bank_mask:0xf
    v_dot2c_f32_bf16_dpp v18, v48, v169 row_newbcast:5 row_mask:0xf bank_mask:0xf
    v_dot2c_f32_bf16_dpp v19, v49, v169 row_newbcast:5 row_mask:0xf bank_mask:0xf
    v_dot2c_f32_bf16_dpp v20, v48, v170 row_newbcast:5 row_mask:0xf bank_mask:0xf
    v_dot2c_f32_bf16_dpp v21, v49, v170 row_newbcast:5 row_mask:0xf bank_mask:0xf
    v_dot2c_f32_bf16_dpp v22, v48, v171 row_newbcast:5 row_mask:0xf bank_mask:0xf
    v_dot2c_f32_bf16_dpp v23, v49, v171 row_newbcast:5 row_mask:0xf bank_mask:0xf
    v_dot2c_f32_bf16_dpp v16, v48, v172 row_newbcast:13 row_mask:0xf bank_mask:0xf
    v_dot2c_f32_bf16_dpp v17, v49, v172 row_newbcast:13 row_mask:0xf bank_mask:0xf
    v_dot2c_f32_bf16_dpp v18, v48, v173 row_newbcast:13 row_mask:0xf bank_mask:0xf
    v_dot2c_f32_bf16_dpp v19, v49, v173 row_newbcast:13 row_mask:0xf bank_mask:0xf
    v_dot2c_f32_bf16_dpp v20, v48, v174 row_newbcast:13 row_mask:0xf bank_mask:0xf
    v_dot2c_f32_bf16_dpp v21, v49, v174 row_newbcast:13 row_mask:0xf bank_mask:0xf
    v_dot2c_f32_bf16_dpp v22, v48, v175 row_newbcast:13 row_mask:0xf bank_mask:0xf
    v_dot2c_f32_bf16_dpp v23, v49, v175 row_newbcast:13 row_mask:0xf bank_mask:0xf
    s_waitcnt vmcnt(19)
    buffer_load_dwordx4 v[132:135], v1, s[20:23], s49 offen offset:1024 nt
    buffer_load_dwordx4 v[136:139], v1, s[20:23], s49 offen offset:2048 nt
    v_dot2c_f32_bf16_dpp v16, v48, v176 row_newbcast:3 row_mask:0xf bank_mask:0xf
    v_dot2c_f32_bf16_dpp v17, v49, v176 row_newbcast:3 row_mask:0xf bank_mask:0xf
    v_dot2c_f32_bf16_dpp v18, v48, v177 row_newbcast:3 row_mask:0xf bank_mask:0xf
    v_dot2c_f32_bf16_dpp v19, v49, v177 row_newbcast:3 row_mask:0xf bank_mask:0xf
    v_dot2c_f32_bf16_dpp v20, v48, v178 row_newbcast:3 row_mask:0xf bank_mask:0xf
    v_dot2c_f32_bf16_dpp v21, v49, v178 row_newbcast:3 row_mask:0xf bank_mask:0xf
    v_dot2c_f32_bf16_dpp v22, v48, v179 row_newbcast:3 row_mask:0xf bank_mask:0xf
    v_dot2c_f32_bf16_dpp v23, v49, v179 row_newbcast:3 row_mask:0xf bank_mask:0xf
    v_dot2c_f32_bf16_dpp v16, v48, v180 row_newbcast:11 row_mask:0xf bank_mask:0xf
    v_dot2c_f32_bf16_dpp v17, v49, v180 row_newbcast:11 row_mask:0xf bank_mask:0xf
    v_dot2c_f32_bf16_dpp v18, v48, v181 row_newbcast:11 row_mask:0xf bank_mask:0xf
    v_dot2c_f32_bf16_dpp v19, v49, v181 row_newbcast:11 row_mask:0xf bank_mask:0xf
    v_dot2c_f32_bf16_dpp v20, v48, v182 row_newbcast:11 row_mask:0xf bank_mask:0xf
    v_dot2c_f32_bf16_dpp v21, v49, v182 row_newbcast:11 row_mask:0xf bank_mask:0xf
    v_dot2c_f32_bf16_dpp v22, v48, v183 row_newbcast:11 row_mask:0xf bank_mask:0xf
    v_dot2c_f32_bf16_dpp v23, v49, v183 row_newbcast:11 row_mask:0xf bank_mask:0xf
    s_waitcnt vmcnt(19)
    buffer_load_dwordx4 v[140:143], v1, s[20:23], s49 offen offset:3072 nt
    buffer_load_dwordx4 v[144:147], v2, s[20:23], s49 offen offset:0 nt
    v_dot2c_f32_bf16_dpp v16, v48, v184 row_newbcast:7 row_mask:0xf bank_mask:0xf
    v_dot2c_f32_bf16_dpp v17, v49, v184 row_newbcast:7 row_mask:0xf bank_mask:0xf
    v_dot2c_f32_bf16_dpp v18, v48, v185 row_newbcast:7 row_mask:0xf bank_mask:0xf
    v_dot2c_f32_bf16_dpp v19, v49, v185 row_newbcast:7 row_mask:0xf bank_mask:0xf
    v_dot2c_f32_bf16_dpp v20, v48, v186 row_newbcast:7 row_mask:0xf bank_mask:0xf
    v_dot2c_f32_bf16_dpp v21, v49, v186 row_newbcast:7 row_mask:0xf bank_mask:0xf
    v_dot2c_f32_bf16_dpp v22, v48, v187 row_newbcast:7 row_mask:0xf bank_mask:0xf
    v_dot2c_f32_bf16_dpp v23, v49, v187 row_newbcast:7 row_mask:0xf bank_mask:0xf
    v_dot2c_f32_bf16_dpp v16, v48, v188 row_newbcast:15 row_mask:0xf bank_mask:0xf
    v_dot2c_f32_bf16_dpp v17, v49, v188 row_newbcast:15 row_mask:0xf bank_mask:0xf
    v_dot2c_f32_bf16_dpp v18, v48, v189 row_newbcast:15 row_mask:0xf bank_mask:0xf
    v_dot2c_f32_bf16_dpp v19, v49, v189 row_newbcast:15 row_mask:0xf bank_mask:0xf
    v_dot2c_f32_bf16_dpp v20, v48, v190 row_newbcast:15 row_mask:0xf bank_mask:0xf
    v_dot2c_f32_bf16_dpp v21, v49, v190 row_newbcast:15 row_mask:0xf bank_mask:0xf
    v_dot2c_f32_bf16_dpp v22, v48, v191 row_newbcast:15 row_mask:0xf bank_mask:0xf
    v_dot2c_f32_bf16_dpp v23, v49, v191 row_newbcast:15 row_mask:0xf bank_mask:0xf
    s_mov_b32 s12, s20
    s_mov_b32 s13, s21
    s_mov_b32 s47, s49
    s_branch L_kv
L_final:
    buffer_load_dwordx4 v[188:191], v4, s[12:15], s47 offen offset:3072 nt
    s_sub_u32 s72, s57, 40
    s_sub_u32 s53, s72, 4
    s_add_u32 s56, s42, s53
    s_and_b32 s56, s56, 3
    s_add_u32 s56, s56, s64
    s_lshl_b32 s51, s56, 8
    v_add_u32 v236, s51, v7
    s_lshr_b32 s51, s56, 5
    s_lshl_b32 s51, s51, 1
    v_mov_b32 v227, s51
    global_load_dword v224, v236, s[24:25]
    global_load_dword v225, v236, s[30:31]
    global_load_dword v226, v236, s[32:33]
    global_load_ushort v227, v227, s[34:35]
    s_add_u32 s52, s42, 0
    s_and_b32 s52, s52, 3
    s_add_u32 s52, s52, s64
    s_lshl_b32 s51, s52, 3
    s_add_u32 s51, s51, s43
    s_lshl_b32 s51, s51, 10
    s_add_u32 s51, s51, 1048576
    v_add_u32 v228, s51, v1
    global_store_dwordx4 v228, v[240:243], s[40:41] sc0 sc1
    s_add_u32 s52, s42, 1
    s_and_b32 s52, s52, 3
    s_add_u32 s52, s52, s64
    s_lshl_b32 s51, s52, 3
    s_add_u32 s51, s51, s43
    s_lshl_b32 s51, s51, 10
    s_add_u32 s51, s51, 1048576
    v_add_u32 v229, s51, v1
    global_store_dwordx4 v229, v[244:247], s[40:41] sc0 sc1
    s_add_u32 s52, s42, 2
    s_and_b32 s52, s52, 3
    s_add_u32 s52, s52, s64
    s_lshl_b32 s51, s52, 3
    s_add_u32 s51, s51, s43
    s_lshl_b32 s51, s51, 10
    s_add_u32 s51, s51, 1048576
    v_add_u32 v230, s51, v1
    global_store_dwordx4 v230, v[248:251], s[40:41] sc0 sc1
    s_add_u32 s52, s43, 3
    s_and_b32 s52, s52, 7
    s_lshl_b32 s51, s56, 3
    s_add_u32 s51, s51, s52
    s_lshl_b32 s51, s51, 10
    s_add_u32 s51, s51, 1048576
    v_add_u32 v231, s51, v1
    s_add_u32 s52, s43, 4
    s_and_b32 s52, s52, 7
    s_lshl_b32 s51, s56, 3
    s_add_u32 s51, s51, s52
    s_lshl_b32 s51, s51, 10
    s_add_u32 s51, s51, 1048576
    v_add_u32 v232, s51, v1
    s_add_u32 s52, s43, 5
    s_and_b32 s52, s52, 7
    s_lshl_b32 s51, s56, 3
    s_add_u32 s51, s51, s52
    s_lshl_b32 s51, s51, 10
    s_add_u32 s51, s51, 1048576
    v_add_u32 v233, s51, v1
    s_add_u32 s52, s43, 6
    s_and_b32 s52, s52, 7
    s_lshl_b32 s51, s56, 3
    s_add_u32 s51, s51, s52
    s_lshl_b32 s51, s51, 10
    s_add_u32 s51, s51, 1048576
    v_add_u32 v234, s51, v1
    s_add_u32 s52, s43, 7
    s_and_b32 s52, s52, 7
    s_lshl_b32 s51, s56, 3
    s_add_u32 s51, s51, s52
    s_lshl_b32 s51, s51, 10
    s_add_u32 s51, s51, 1048576
    v_add_u32 v235, s51, v1
    s_nop 0
    s_add_u32 s52, s43, 1
    s_and_b32 s52, s52, 7
    s_lshl_b32 s51, s56, 3
    s_add_u32 s51, s51, s52
    s_lshl_b32 s51, s51, 10
    s_add_u32 s51, s51, 1048576
    v_add_u32 v229, s51, v1
    s_add_u32 s52, s43, 2
    s_and_b32 s52, s52, 7
    s_lshl_b32 s51, s56, 3
    s_add_u32 s51, s51, s52
    s_lshl_b32 s51, s51, 10
    s_add_u32 s51, s51, 1048576
    v_add_u32 v230, s51, v1
    v_dot2_f32_bf16 v34, v104, v8, 0
    v_dot2_f32_bf16 v35, v108, v8, 0
    v_dot2_f32_bf16 v34, v105, v9, v34
    v_dot2_f32_bf16 v35, v109, v9, v35
    v_dot2_f32_bf16 v34, v106, v10, v34
    v_dot2_f32_bf16 v35, v110, v10, v35
    v_dot2_f32_bf16 v34, v107, v11, v34
    v_dot2_f32_bf16 v35, v111, v11, v35
    v_add_f32_dpp v32, v32, v32 row_ror:8 row_mask:0xf bank_mask:0x3
    v_add_f32_dpp v32, v33, v33 row_ror:8 row_mask:0xf bank_mask:0xc
    v_add_f32_dpp v28, v28, v28 row_shl:4 row_mask:0xf bank_mask:0x5
    v_add_f32_dpp v28, v30, v30 row_shr:4 row_mask:0xf bank_mask:0xa
    s_waitcnt vmcnt(25)
    v_dot2_f32_bf16 v36, v112, v8, 0
    v_dot2_f32_bf16 v37, v116, v8, 0
    v_dot2_f32_bf16 v36, v113, v9, v36
    v_dot2_f32_bf16 v37, v117, v9, v37
    v_dot2_f32_bf16 v36, v114, v10, v36
    v_dot2_f32_bf16 v37, v118, v10, v37
    v_dot2_f32_bf16 v36, v115, v11, v36
    v_dot2_f32_bf16 v37, v119, v11, v37
    v_add_f32_dpp v34, v34, v34 row_ror:8 row_mask:0xf bank_mask:0x3
    v_add_f32_dpp v34, v35, v35 row_ror:8 row_mask:0xf bank_mask:0xc
    v_add_f32_dpp v40, v24, v24 quad_perm:[2,3,0,1] row_mask:0xf bank_mask:0xf
    v_add_f32_dpp v41, v28, v28 quad_perm:[2,3,0,1] row_mask:0xf bank_mask:0xf
    v_cndmask_b32 v24, v40, v41, s[60:61]
    s_waitcnt vmcnt(23)
    v_dot2_f32_bf16 v38, v120, v8, 0
    v_dot2_f32_bf16 v39, v124, v8, 0
    v_dot2_f32_bf16 v38, v121, v9, v38
    v_dot2_f32_bf16 v39, v125, v9, v39
    v_dot2_f32_bf16 v38, v122, v10, v38
    v_dot2_f32_bf16 v39, v126, v10, v39
    v_dot2_f32_bf16 v38, v123, v11, v38
    v_dot2_f32_bf16 v39, v127, v11, v39
    v_add_f32_dpp v36, v36, v36 row_ror:8 row_mask:0xf bank_mask:0x3
    v_add_f32_dpp v36, v37, v37 row_ror:8 row_mask:0xf bank_mask:0xc
    v_add_f32_dpp v32, v32, v32 row_shl:4 row_mask:0xf bank_mask:0x5
    v_add_f32_dpp v32, v34, v34 row_shr:4 row_mask:0xf bank_mask:0xa
    v_add_f32_dpp v38, v38, v38 row_ror:8 row_mask:0xf bank_mask:0x3
    v_add_f32_dpp v38, v39, v39 row_ror:8 row_mask:0xf bank_mask:0xc
    v_add_f32_dpp v36, v36, v36 row_shl:4 row_mask:0xf bank_mask:0x5
    s_nop 0
    v_add_f32_dpp v36, v38, v38 row_shr:4 row_mask:0xf bank_mask:0xa
    v_add_f32_dpp v40, v32, v32 quad_perm:[2,3,0,1] row_mask:0xf bank_mask:0xf
    s_nop 0
    v_add_f32_dpp v41, v36, v36 quad_perm:[2,3,0,1] row_mask:0xf bank_mask:0xf
    v_cndmask_b32 v32, v40, v41, s[60:61]
    v_add_f32_dpp v40, v24, v24 quad_perm:[1,0,3,2] row_mask:0xf bank_mask:0xf
    s_nop 0
    v_add_f32_dpp v41, v32, v32 quad_perm:[1,0,3,2] row_mask:0xf bank_mask:0xf
    v_cndmask_b32 v40, v40, v41, s[62:63]
    v_mul_f32 v40, s50, v40
    s_nop 1
    v_max_f32_dpp v41, v40, v40 row_ror:8 row_mask:0xf bank_mask:0xf
    s_nop 1
    v_max_f32_dpp v41, v41, v41 row_ror:4 row_mask:0xf bank_mask:0xf
    s_nop 1
    v_max_f32_dpp v41, v41, v41 row_ror:2 row_mask:0xf bank_mask:0xf
    s_nop 1
    v_max_f32_dpp v41, v41, v41 row_ror:1 row_mask:0xf bank_mask:0xf
    v_max_f32 v53, v5, v41
    v_sub_f32 v52, v5, v53
    v_sub_f32 v40, v40, v53
    v_exp_f32 v52, v52
    v_exp_f32 v40, v40
    v_mov_b32 v5, v53
    v_cvt_pk_bf16_f32 v48, v40, 0
    v_cvt_pk_bf16_f32 v49, 0, v40
    v_fma_f32 v6, v6, v52, v40
    v_mul_f32 v16, v52, v16
    v_mul_f32 v17, v52, v17
    v_mul_f32 v18, v52, v18
    v_mul_f32 v19, v52, v19
    v_mul_f32 v20, v52, v20
    v_mul_f32 v21, v52, v21
    v_mul_f32 v22, v52, v22
    v_mul_f32 v23, v52, v23
    s_waitcnt vmcnt(21)
    v_dot2c_f32_bf16_dpp v16, v48, v128 row_newbcast:0 row_mask:0xf bank_mask:0xf
    v_dot2c_f32_bf16_dpp v17, v49, v128 row_newbcast:0 row_mask:0xf bank_mask:0xf
    v_dot2c_f32_bf16_dpp v18, v48, v129 row_newbcast:0 row_mask:0xf bank_mask:0xf
    v_dot2c_f32_bf16_dpp v19, v49, v129 row_newbcast:0 row_mask:0xf bank_mask:0xf
    v_dot2c_f32_bf16_dpp v20, v48, v130 row_newbcast:0 row_mask:0xf bank_mask:0xf
    v_dot2c_f32_bf16_dpp v21, v49, v130 row_newbcast:0 row_mask:0xf bank_mask:0xf
    v_dot2c_f32_bf16_dpp v22, v48, v131 row_newbcast:0 row_mask:0xf bank_mask:0xf
    v_dot2c_f32_bf16_dpp v23, v49, v131 row_newbcast:0 row_mask:0xf bank_mask:0xf
    v_dot2c_f32_bf16_dpp v16, v48, v132 row_newbcast:8 row_mask:0xf bank_mask:0xf
    v_dot2c_f32_bf16_dpp v17, v49, v132 row_newbcast:8 row_mask:0xf bank_mask:0xf
    v_dot2c_f32_bf16_dpp v18, v48, v133 row_newbcast:8 row_mask:0xf bank_mask:0xf
    v_dot2c_f32_bf16_dpp v19, v49, v133 row_newbcast:8 row_mask:0xf bank_mask:0xf
    v_dot2c_f32_bf16_dpp v20, v48, v134 row_newbcast:8 row_mask:0xf bank_mask:0xf
    v_dot2c_f32_bf16_dpp v21, v49, v134 row_newbcast:8 row_mask:0xf bank_mask:0xf
    v_dot2c_f32_bf16_dpp v22, v48, v135 row_newbcast:8 row_mask:0xf bank_mask:0xf
    v_dot2c_f32_bf16_dpp v23, v49, v135 row_newbcast:8 row_mask:0xf bank_mask:0xf
    s_waitcnt vmcnt(19)
    v_dot2c_f32_bf16_dpp v16, v48, v136 row_newbcast:4 row_mask:0xf bank_mask:0xf
    v_dot2c_f32_bf16_dpp v17, v49, v136 row_newbcast:4 row_mask:0xf bank_mask:0xf
    v_dot2c_f32_bf16_dpp v18, v48, v137 row_newbcast:4 row_mask:0xf bank_mask:0xf
    v_dot2c_f32_bf16_dpp v19, v49, v137 row_newbcast:4 row_mask:0xf bank_mask:0xf
    v_dot2c_f32_bf16_dpp v20, v48, v138 row_newbcast:4 row_mask:0xf bank_mask:0xf
    v_dot2c_f32_bf16_dpp v21, v49, v138 row_newbcast:4 row_mask:0xf bank_mask:0xf
    v_dot2c_f32_bf16_dpp v22, v48, v139 row_newbcast:4 row_mask:0xf bank_mask:0xf
    v_dot2c_f32_bf16_dpp v23, v49, v139 row_newbcast:4 row_mask:0xf bank_mask:0xf
    v_dot2c_f32_bf16_dpp v16, v48, v140 row_newbcast:12 row_mask:0xf bank_mask:0xf
    v_dot2c_f32_bf16_dpp v17, v49, v140 row_newbcast:12 row_mask:0xf bank_mask:0xf
    v_dot2c_f32_bf16_dpp v18, v48, v141 row_newbcast:12 row_mask:0xf bank_mask:0xf
    v_dot2c_f32_bf16_dpp v19, v49, v141 row_newbcast:12 row_mask:0xf bank_mask:0xf
    v_dot2c_f32_bf16_dpp v20, v48, v142 row_newbcast:12 row_mask:0xf bank_mask:0xf
    v_dot2c_f32_bf16_dpp v21, v49, v142 row_newbcast:12 row_mask:0xf bank_mask:0xf
    v_dot2c_f32_bf16_dpp v22, v48, v143 row_newbcast:12 row_mask:0xf bank_mask:0xf
    v_dot2c_f32_bf16_dpp v23, v49, v143 row_newbcast:12 row_mask:0xf bank_mask:0xf
    s_waitcnt vmcnt(17)
    v_dot2c_f32_bf16_dpp v16, v48, v144 row_newbcast:2 row_mask:0xf bank_mask:0xf
    v_dot2c_f32_bf16_dpp v17, v49, v144 row_newbcast:2 row_mask:0xf bank_mask:0xf
    v_dot2c_f32_bf16_dpp v18, v48, v145 row_newbcast:2 row_mask:0xf bank_mask:0xf
    v_dot2c_f32_bf16_dpp v19, v49, v145 row_newbcast:2 row_mask:0xf bank_mask:0xf
    v_dot2c_f32_bf16_dpp v20, v48, v146 row_newbcast:2 row_mask:0xf bank_mask:0xf
    v_dot2c_f32_bf16_dpp v21, v49, v146 row_newbcast:2 row_mask:0xf bank_mask:0xf
    v_dot2c_f32_bf16_dpp v22, v48, v147 row_newbcast:2 row_mask:0xf bank_mask:0xf
    v_dot2c_f32_bf16_dpp v23, v49, v147 row_newbcast:2 row_mask:0xf bank_mask:0xf
    v_dot2c_f32_bf16_dpp v16, v48, v148 row_newbcast:10 row_mask:0xf bank_mask:0xf
    v_dot2c_f32_bf16_dpp v17, v49, v148 row_newbcast:10 row_mask:0xf bank_mask:0xf
    v_dot2c_f32_bf16_dpp v18, v48, v149 row_newbcast:10 row_mask:0xf bank_mask:0xf
    v_dot2c_f32_bf16_dpp v19, v49, v149 row_newbcast:10 row_mask:0xf bank_mask:0xf
    v_dot2c_f32_bf16_dpp v20, v48, v150 row_newbcast:10 row_mask:0xf bank_mask:0xf
    v_dot2c_f32_bf16_dpp v21, v49, v150 row_newbcast:10 row_mask:0xf bank_mask:0xf
    v_dot2c_f32_bf16_dpp v22, v48, v151 row_newbcast:10 row_mask:0xf bank_mask:0xf
    v_dot2c_f32_bf16_dpp v23, v49, v151 row_newbcast:10 row_mask:0xf bank_mask:0xf
    s_waitcnt vmcnt(15)
    v_dot2c_f32_bf16_dpp v16, v48, v152 row_newbcast:6 row_mask:0xf bank_mask:0xf
    v_dot2c_f32_bf16_dpp v17, v49, v152 row_newbcast:6 row_mask:0xf bank_mask:0xf
    v_dot2c_f32_bf16_dpp v18, v48, v153 row_newbcast:6 row_mask:0xf bank_mask:0xf
    v_dot2c_f32_bf16_dpp v19, v49, v153 row_newbcast:6 row_mask:0xf bank_mask:0xf
    v_dot2c_f32_bf16_dpp v20, v48, v154 row_newbcast:6 row_mask:0xf bank_mask:0xf
    v_dot2c_f32_bf16_dpp v21, v49, v154 row_newbcast:6 row_mask:0xf bank_mask:0xf
    v_dot2c_f32_bf16_dpp v22, v48, v155 row_newbcast:6 row_mask:0xf bank_mask:0xf
    v_dot2c_f32_bf16_dpp v23, v49, v155 row_newbcast:6 row_mask:0xf bank_mask:0xf
    v_dot2c_f32_bf16_dpp v16, v48, v156 row_newbcast:14 row_mask:0xf bank_mask:0xf
    v_dot2c_f32_bf16_dpp v17, v49, v156 row_newbcast:14 row_mask:0xf bank_mask:0xf
    v_dot2c_f32_bf16_dpp v18, v48, v157 row_newbcast:14 row_mask:0xf bank_mask:0xf
    v_dot2c_f32_bf16_dpp v19, v49, v157 row_newbcast:14 row_mask:0xf bank_mask:0xf
    v_dot2c_f32_bf16_dpp v20, v48, v158 row_newbcast:14 row_mask:0xf bank_mask:0xf
    v_dot2c_f32_bf16_dpp v21, v49, v158 row_newbcast:14 row_mask:0xf bank_mask:0xf
    v_dot2c_f32_bf16_dpp v22, v48, v159 row_newbcast:14 row_mask:0xf bank_mask:0xf
    v_dot2c_f32_bf16_dpp v23, v49, v159 row_newbcast:14 row_mask:0xf bank_mask:0xf
    s_waitcnt vmcnt(13)
    v_dot2c_f32_bf16_dpp v16, v48, v160 row_newbcast:1 row_mask:0xf bank_mask:0xf
    v_dot2c_f32_bf16_dpp v17, v49, v160 row_newbcast:1 row_mask:0xf bank_mask:0xf
    v_dot2c_f32_bf16_dpp v18, v48, v161 row_newbcast:1 row_mask:0xf bank_mask:0xf
    v_dot2c_f32_bf16_dpp v19, v49, v161 row_newbcast:1 row_mask:0xf bank_mask:0xf
    v_dot2c_f32_bf16_dpp v20, v48, v162 row_newbcast:1 row_mask:0xf bank_mask:0xf
    v_dot2c_f32_bf16_dpp v21, v49, v162 row_newbcast:1 row_mask:0xf bank_mask:0xf
    v_dot2c_f32_bf16_dpp v22, v48, v163 row_newbcast:1 row_mask:0xf bank_mask:0xf
    v_dot2c_f32_bf16_dpp v23, v49, v163 row_newbcast:1 row_mask:0xf bank_mask:0xf
    v_dot2c_f32_bf16_dpp v16, v48, v164 row_newbcast:9 row_mask:0xf bank_mask:0xf
    v_dot2c_f32_bf16_dpp v17, v49, v164 row_newbcast:9 row_mask:0xf bank_mask:0xf
    v_dot2c_f32_bf16_dpp v18, v48, v165 row_newbcast:9 row_mask:0xf bank_mask:0xf
    v_dot2c_f32_bf16_dpp v19, v49, v165 row_newbcast:9 row_mask:0xf bank_mask:0xf
    v_dot2c_f32_bf16_dpp v20, v48, v166 row_newbcast:9 row_mask:0xf bank_mask:0xf
    v_dot2c_f32_bf16_dpp v21, v49, v166 row_newbcast:9 row_mask:0xf bank_mask:0xf
    v_dot2c_f32_bf16_dpp v22, v48, v167 row_newbcast:9 row_mask:0xf bank_mask:0xf
    v_dot2c_f32_bf16_dpp v23, v49, v167 row_newbcast:9 row_mask:0xf bank_mask:0xf
    s_cmp_ge_u32 s72, 4
    s_cbranch_scc1 L_f_role
    s_waitcnt vmcnt(11)
    v_dot2c_f32_bf16_dpp v16, v48, v168 row_newbcast:5 row_mask:0xf bank_mask:0xf
    v_dot2c_f32_bf16_dpp v17, v49, v168 row_newbcast:5 row_mask:0xf bank_mask:0xf
    v_dot2c_f32_bf16_dpp v18, v48, v169 row_newbcast:5 row_mask:0xf bank_mask:0xf
    v_dot2c_f32_bf16_dpp v19, v49, v169 row_newbcast:5 row_mask:0xf bank_mask:0xf
    v_dot2c_f32_bf16_dpp v20, v48, v170 row_newbcast:5 row_mask:0xf bank_mask:0xf
    v_dot2c_f32_bf16_dpp v21, v49, v170 row_newbcast:5 row_mask:0xf bank_mask:0xf
    v_dot2c_f32_bf16_dpp v22, v48, v171 row_newbcast:5 row_mask:0xf bank_mask:0xf
    v_dot2c_f32_bf16_dpp v23, v49, v171 row_newbcast:5 row_mask:0xf bank_mask:0xf
    v_dot2c_f32_bf16_dpp v16, v48, v172 row_newbcast:13 row_mask:0xf bank_mask:0xf
    v_dot2c_f32_bf16_dpp v17, v49, v172 row_newbcast:13 row_mask:0xf bank_mask:0xf
    v_dot2c_f32_bf16_dpp v18, v48, v173 row_newbcast:13 row_mask:0xf bank_mask:0xf
    v_dot2c_f32_bf16_dpp v19, v49, v173 row_newbcast:13 row_mask:0xf bank_mask:0xf
    v_dot2c_f32_bf16_dpp v20, v48, v174 row_newbcast:13 row_mask:0xf bank_mask:0xf
    v_dot2c_f32_bf16_dpp v21, v49, v174 row_newbcast:13 row_mask:0xf bank_mask:0xf
    v_dot2c_f32_bf16_dpp v22, v48, v175 row_newbcast:13 row_mask:0xf bank_mask:0xf
    v_dot2c_f32_bf16_dpp v23, v49, v175 row_newbcast:13 row_mask:0xf bank_mask:0xf
    s_waitcnt vmcnt(9)
    v_dot2c_f32_bf16_dpp v16, v48, v176 row_newbcast:3 row_mask:0xf bank_mask:0xf
    v_dot2c_f32_bf16_dpp v17, v49, v176 row_newbcast:3 row_mask:0xf bank_mask:0xf
    v_dot2c_f32_bf16_dpp v18, v48, v177 row_newbcast:3 row_mask:0xf bank_mask:0xf
    v_dot2c_f32_bf16_dpp v19, v49, v177 row_newbcast:3 row_mask:0xf bank_mask:0xf
    v_dot2c_f32_bf16_dpp v20, v48, v178 row_newbcast:3 row_mask:0xf bank_mask:0xf
    v_dot2c_f32_bf16_dpp v21, v49, v178 row_newbcast:3 row_mask:0xf bank_mask:0xf
    v_dot2c_f32_bf16_dpp v22, v48, v179 row_newbcast:3 row_mask:0xf bank_mask:0xf
    v_dot2c_f32_bf16_dpp v23, v49, v179 row_newbcast:3 row_mask:0xf bank_mask:0xf
    v_dot2c_f32_bf16_dpp v16, v48, v180 row_newbcast:11 row_mask:0xf bank_mask:0xf
    v_dot2c_f32_bf16_dpp v17, v49, v180 row_newbcast:11 row_mask:0xf bank_mask:0xf
    v_dot2c_f32_bf16_dpp v18, v48, v181 row_newbcast:11 row_mask:0xf bank_mask:0xf
    v_dot2c_f32_bf16_dpp v19, v49, v181 row_newbcast:11 row_mask:0xf bank_mask:0xf
    v_dot2c_f32_bf16_dpp v20, v48, v182 row_newbcast:11 row_mask:0xf bank_mask:0xf
    v_dot2c_f32_bf16_dpp v21, v49, v182 row_newbcast:11 row_mask:0xf bank_mask:0xf
    v_dot2c_f32_bf16_dpp v22, v48, v183 row_newbcast:11 row_mask:0xf bank_mask:0xf
    v_dot2c_f32_bf16_dpp v23, v49, v183 row_newbcast:11 row_mask:0xf bank_mask:0xf
    s_waitcnt vmcnt(7)
    v_dot2c_f32_bf16_dpp v16, v48, v184 row_newbcast:7 row_mask:0xf bank_mask:0xf
    v_dot2c_f32_bf16_dpp v17, v49, v184 row_newbcast:7 row_mask:0xf bank_mask:0xf
    v_dot2c_f32_bf16_dpp v18, v48, v185 row_newbcast:7 row_mask:0xf bank_mask:0xf
    v_dot2c_f32_bf16_dpp v19, v49, v185 row_newbcast:7 row_mask:0xf bank_mask:0xf
    v_dot2c_f32_bf16_dpp v20, v48, v186 row_newbcast:7 row_mask:0xf bank_mask:0xf
    v_dot2c_f32_bf16_dpp v21, v49, v186 row_newbcast:7 row_mask:0xf bank_mask:0xf
    v_dot2c_f32_bf16_dpp v22, v48, v187 row_newbcast:7 row_mask:0xf bank_mask:0xf
    v_dot2c_f32_bf16_dpp v23, v49, v187 row_newbcast:7 row_mask:0xf bank_mask:0xf
    v_dot2c_f32_bf16_dpp v16, v48, v188 row_newbcast:15 row_mask:0xf bank_mask:0xf
    v_dot2c_f32_bf16_dpp v17, v49, v188 row_newbcast:15 row_mask:0xf bank_mask:0xf
    v_dot2c_f32_bf16_dpp v18, v48, v189 row_newbcast:15 row_mask:0xf bank_mask:0xf
    v_dot2c_f32_bf16_dpp v19, v49, v189 row_newbcast:15 row_mask:0xf bank_mask:0xf
    v_dot2c_f32_bf16_dpp v20, v48, v190 row_newbcast:15 row_mask:0xf bank_mask:0xf
    v_dot2c_f32_bf16_dpp v21, v49, v190 row_newbcast:15 row_mask:0xf bank_mask:0xf
    v_dot2c_f32_bf16_dpp v22, v48, v191 row_newbcast:15 row_mask:0xf bank_mask:0xf
    v_dot2c_f32_bf16_dpp v23, v49, v191 row_newbcast:15 row_mask:0xf bank_mask:0xf
    s_nop 2
    v_mov_b32 v58, v5
    v_mov_b32 v59, v5
    s_nop 1
    v_permlane32_swap_b32 v58, v59
    v_max_f32 v58, v58, v59
    v_mov_b32 v59, v58
    s_nop 1
    v_permlane16_swap_b32 v58, v59
    v_max_f32 v53, v58, v59
    v_sub_f32 v52, v5, v53
    v_exp_f32 v52, v52
    s_nop 0
    v_mul_f32 v6, v52, v6
    v_mul_f32 v16, v52, v16
    v_mul_f32 v17, v52, v17
    v_mul_f32 v18, v52, v18
    v_mul_f32 v19, v52, v19
    v_mul_f32 v20, v52, v20
    v_mul_f32 v21, v52, v21
    v_mul_f32 v22, v52, v22
    v_mul_f32 v23, v52, v23
    v_add_f32_dpp v6, v6, v6 row_ror:8 row_mask:0xf bank_mask:0xf
    v_permlane32_swap_b32 v16, v20
    v_permlane32_swap_b32 v17, v21
    v_permlane32_swap_b32 v18, v22
    v_permlane32_swap_b32 v19, v23
    v_add_f32_dpp v6, v6, v6 row_ror:4 row_mask:0xf bank_mask:0xf
    v_add_f32 v16, v16, v20
    v_add_f32 v17, v17, v21
    v_add_f32 v18, v18, v22
    v_add_f32 v19, v19, v23
    v_add_f32_dpp v6, v6, v6 row_ror:2 row_mask:0xf bank_mask:0xf
    s_nop 0
    v_permlane16_swap_b32 v16, v18
    v_permlane16_swap_b32 v17, v19
    v_add_f32_dpp v6, v6, v6 row_ror:1 row_mask:0xf bank_mask:0xf
    v_add_f32 v16, v16, v18
    v_add_f32 v17, v17, v19
    v_mov_b32 v58, v6
    s_nop 1
    v_permlane32_swap_b32 v58, v6
    v_add_f32 v6, v58, v6
    v_mov_b32 v58, v6
    s_nop 1
    v_permlane16_swap_b32 v58, v6
    v_add_f32 v19, v58, v6
    v_mov_b32 v18, v53
    s_lshr_b32 s52, s70, 21
    s_add_u32 s52, s52, s64
    s_lshl_b32 s51, s52, 3
    s_add_u32 s51, s51, s43
    s_lshl_b32 s51, s51, 10
    s_add_u32 s51, s51, 1048576
    v_add_u32 v40, s51, v1
    global_store_dwordx4 v40, v[16:19], s[40:41] sc0 sc1
    s_branch L_fin
L_f_role:
    s_waitcnt vmcnt(11)
    global_load_dwordx4 v[196:199], v229, s[40:41] sc0 sc1
    global_load_dwordx4 v[200:203], v230, s[40:41] sc0 sc1
    global_load_dwordx4 v[204:207], v231, s[40:41] sc0 sc1
    global_load_dwordx4 v[208:211], v232, s[40:41] sc0 sc1
    global_load_dwordx4 v[212:215], v233, s[40:41] sc0 sc1
    global_load_dwordx4 v[216:219], v234, s[40:41] sc0 sc1
    global_load_dwordx4 v[220:223], v235, s[40:41] sc0 sc1
    v_dot2c_f32_bf16_dpp v16, v48, v168 row_newbcast:5 row_mask:0xf bank_mask:0xf
    v_dot2c_f32_bf16_dpp v17, v49, v168 row_newbcast:5 row_mask:0xf bank_mask:0xf
    v_dot2c_f32_bf16_dpp v18, v48, v169 row_newbcast:5 row_mask:0xf bank_mask:0xf
    v_dot2c_f32_bf16_dpp v19, v49, v169 row_newbcast:5 row_mask:0xf bank_mask:0xf
    v_dot2c_f32_bf16_dpp v20, v48, v170 row_newbcast:5 row_mask:0xf bank_mask:0xf
    v_dot2c_f32_bf16_dpp v21, v49, v170 row_newbcast:5 row_mask:0xf bank_mask:0xf
    v_dot2c_f32_bf16_dpp v22, v48, v171 row_newbcast:5 row_mask:0xf bank_mask:0xf
    v_dot2c_f32_bf16_dpp v23, v49, v171 row_newbcast:5 row_mask:0xf bank_mask:0xf
    v_dot2c_f32_bf16_dpp v16, v48, v172 row_newbcast:13 row_mask:0xf bank_mask:0xf
    v_dot2c_f32_bf16_dpp v17, v49, v172 row_newbcast:13 row_mask:0xf bank_mask:0xf
    v_dot2c_f32_bf16_dpp v18, v48, v173 row_newbcast:13 row_mask:0xf bank_mask:0xf
    v_dot2c_f32_bf16_dpp v19, v49, v173 row_newbcast:13 row_mask:0xf bank_mask:0xf
    v_dot2c_f32_bf16_dpp v20, v48, v174 row_newbcast:13 row_mask:0xf bank_mask:0xf
    v_dot2c_f32_bf16_dpp v21, v49, v174 row_newbcast:13 row_mask:0xf bank_mask:0xf
    v_dot2c_f32_bf16_dpp v22, v48, v175 row_newbcast:13 row_mask:0xf bank_mask:0xf
    v_dot2c_f32_bf16_dpp v23, v49, v175 row_newbcast:13 row_mask:0xf bank_mask:0xf
    s_waitcnt vmcnt(16)
    v_dot2c_f32_bf16_dpp v16, v48, v176 row_newbcast:3 row_mask:0xf bank_mask:0xf
    v_dot2c_f32_bf16_dpp v17, v49, v176 row_newbcast:3 row_mask:0xf bank_mask:0xf
    v_dot2c_f32_bf16_dpp v18, v48, v177 row_newbcast:3 row_mask:0xf bank_mask:0xf
    v_dot2c_f32_bf16_dpp v19, v49, v177 row_newbcast:3 row_mask:0xf bank_mask:0xf
    v_dot2c_f32_bf16_dpp v20, v48, v178 row_newbcast:3 row_mask:0xf bank_mask:0xf
    v_dot2c_f32_bf16_dpp v21, v49, v178 row_newbcast:3 row_mask:0xf bank_mask:0xf
    v_dot2c_f32_bf16_dpp v22, v48, v179 row_newbcast:3 row_mask:0xf bank_mask:0xf
    v_dot2c_f32_bf16_dpp v23, v49, v179 row_newbcast:3 row_mask:0xf bank_mask:0xf
    v_dot2c_f32_bf16_dpp v16, v48, v180 row_newbcast:11 row_mask:0xf bank_mask:0xf
    v_dot2c_f32_bf16_dpp v17, v49, v180 row_newbcast:11 row_mask:0xf bank_mask:0xf
    v_dot2c_f32_bf16_dpp v18, v48, v181 row_newbcast:11 row_mask:0xf bank_mask:0xf
    v_dot2c_f32_bf16_dpp v19, v49, v181 row_newbcast:11 row_mask:0xf bank_mask:0xf
    v_dot2c_f32_bf16_dpp v20, v48, v182 row_newbcast:11 row_mask:0xf bank_mask:0xf
    v_dot2c_f32_bf16_dpp v21, v49, v182 row_newbcast:11 row_mask:0xf bank_mask:0xf
    v_dot2c_f32_bf16_dpp v22, v48, v183 row_newbcast:11 row_mask:0xf bank_mask:0xf
    v_dot2c_f32_bf16_dpp v23, v49, v183 row_newbcast:11 row_mask:0xf bank_mask:0xf
    s_waitcnt vmcnt(14)
    v_dot2c_f32_bf16_dpp v16, v48, v184 row_newbcast:7 row_mask:0xf bank_mask:0xf
    v_dot2c_f32_bf16_dpp v17, v49, v184 row_newbcast:7 row_mask:0xf bank_mask:0xf
    v_dot2c_f32_bf16_dpp v18, v48, v185 row_newbcast:7 row_mask:0xf bank_mask:0xf
    v_dot2c_f32_bf16_dpp v19, v49, v185 row_newbcast:7 row_mask:0xf bank_mask:0xf
    v_dot2c_f32_bf16_dpp v20, v48, v186 row_newbcast:7 row_mask:0xf bank_mask:0xf
    v_dot2c_f32_bf16_dpp v21, v49, v186 row_newbcast:7 row_mask:0xf bank_mask:0xf
    v_dot2c_f32_bf16_dpp v22, v48, v187 row_newbcast:7 row_mask:0xf bank_mask:0xf
    v_dot2c_f32_bf16_dpp v23, v49, v187 row_newbcast:7 row_mask:0xf bank_mask:0xf
    v_dot2c_f32_bf16_dpp v16, v48, v188 row_newbcast:15 row_mask:0xf bank_mask:0xf
    v_dot2c_f32_bf16_dpp v17, v49, v188 row_newbcast:15 row_mask:0xf bank_mask:0xf
    v_dot2c_f32_bf16_dpp v18, v48, v189 row_newbcast:15 row_mask:0xf bank_mask:0xf
    v_dot2c_f32_bf16_dpp v19, v49, v189 row_newbcast:15 row_mask:0xf bank_mask:0xf
    v_dot2c_f32_bf16_dpp v20, v48, v190 row_newbcast:15 row_mask:0xf bank_mask:0xf
    v_dot2c_f32_bf16_dpp v21, v49, v190 row_newbcast:15 row_mask:0xf bank_mask:0xf
    v_dot2c_f32_bf16_dpp v22, v48, v191 row_newbcast:15 row_mask:0xf bank_mask:0xf
    v_dot2c_f32_bf16_dpp v23, v49, v191 row_newbcast:15 row_mask:0xf bank_mask:0xf
    s_nop 2
    v_mov_b32 v58, v5
    v_mov_b32 v59, v5
    s_nop 1
    v_permlane32_swap_b32 v58, v59
    v_max_f32 v58, v58, v59
    v_mov_b32 v59, v58
    s_nop 1
    v_permlane16_swap_b32 v58, v59
    v_max_f32 v53, v58, v59
    v_sub_f32 v52, v5, v53
    v_exp_f32 v52, v52
    s_nop 0
    v_mul_f32 v6, v52, v6
    v_mul_f32 v16, v52, v16
    v_mul_f32 v17, v52, v17
    v_mul_f32 v18, v52, v18
    v_mul_f32 v19, v52, v19
    v_mul_f32 v20, v52, v20
    v_mul_f32 v21, v52, v21
    v_mul_f32 v22, v52, v22
    v_mul_f32 v23, v52, v23
    v_add_f32_dpp v6, v6, v6 row_ror:8 row_mask:0xf bank_mask:0xf
    v_permlane32_swap_b32 v16, v20
    v_permlane32_swap_b32 v17, v21
    v_permlane32_swap_b32 v18, v22
    v_permlane32_swap_b32 v19, v23
    v_add_f32_dpp v6, v6, v6 row_ror:4 row_mask:0xf bank_mask:0xf
    v_add_f32 v16, v16, v20
    v_add_f32 v17, v17, v21
    v_add_f32 v18, v18, v22
    v_add_f32 v19, v19, v23
    v_add_f32_dpp v6, v6, v6 row_ror:2 row_mask:0xf bank_mask:0xf
    s_nop 0
    v_permlane16_swap_b32 v16, v18
    v_permlane16_swap_b32 v17, v19
    v_add_f32_dpp v6, v6, v6 row_ror:1 row_mask:0xf bank_mask:0xf
    v_add_f32 v16, v16, v18
    v_add_f32 v17, v17, v19
    v_mov_b32 v58, v6
    s_nop 1
    v_permlane32_swap_b32 v58, v6
    v_add_f32 v6, v58, v6
    v_mov_b32 v58, v6
    s_nop 1
    v_permlane16_swap_b32 v58, v6
    v_add_f32 v19, v58, v6
    v_mov_b32 v18, v53
    s_cmp_eq_u32 s72, 7
    s_cbranch_scc1 L_c_dyn
    s_lshr_b32 s52, s70, 21
    s_add_u32 s52, s52, s64
    s_lshl_b32 s51, s52, 3
    s_add_u32 s51, s51, s43
    s_lshl_b32 s51, s51, 10
    s_add_u32 s51, s51, 1048576
    v_add_u32 v40, s51, v1
    global_store_dwordx4 v40, v[16:19], s[40:41] sc0 sc1
    s_cmp_eq_u32 s72, 5
    s_cbranch_scc1 L_c_h1
    s_cmp_eq_u32 s72, 6
    s_cbranch_scc1 L_c_h2
    v_mov_b32 v192, v240
    v_mov_b32 v193, v241
    v_mov_b32 v194, v242
    v_mov_b32 v195, v243
    s_branch L_c_st
L_c_h1:
    v_mov_b32 v192, v244
    v_mov_b32 v193, v245
    v_mov_b32 v194, v246
    v_mov_b32 v195, v247
    s_branch L_c_st
L_c_h2:
    v_mov_b32 v192, v248
    v_mov_b32 v193, v249
    v_mov_b32 v194, v250
    v_mov_b32 v195, v251
L_c_st:
    s_waitcnt vmcnt(11)
    v_dot2_f32_bf16 v228, v224, v225, 0
    v_lshlrev_b32 v227, 16, v227
    v_sub_f32 v227, 1.0, v227
    v_mul_f32 v227, 0xceabfb8f, v227
    s_nop 0
    v_add_f32_dpp v228, v228, v228 row_ror:8 row_mask:0xf bank_mask:0xf
    s_nop 1
    v_add_f32_dpp v228, v228, v228 row_ror:4 row_mask:0xf bank_mask:0xf
    s_nop 1
    v_add_f32_dpp v228, v228, v228 row_ror:2 row_mask:0xf bank_mask:0xf
    s_nop 1
    v_add_f32_dpp v228, v228, v228 row_ror:1 row_mask:0xf bank_mask:0xf
    v_mov_b32 v236, v228
    s_nop 1
    v_permlane32_swap_b32 v236, v228
    v_add_f32 v228, v236, v228
    v_mov_b32 v236, v228
    s_nop 1
    v_permlane16_swap_b32 v236, v228
    v_add_f32 v228, v236, v228
    v_fma_f32 v228, v228, s50, v227
    v_lshlrev_b32 v236, 16, v226
    v_and_b32 v237, 0xffff0000, v226
    s_waitcnt vmcnt(1)
    s_branch L_chk
L_c_dyn:
    v_mov_b32 v192, v16
    v_mov_b32 v193, v17
    v_mov_b32 v194, v18
    v_mov_b32 v195, v19
    s_waitcnt vmcnt(10)
    v_dot2_f32_bf16 v228, v224, v225, 0
    v_lshlrev_b32 v227, 16, v227
    v_sub_f32 v227, 1.0, v227
    v_mul_f32 v227, 0xceabfb8f, v227
    s_nop 0
    v_add_f32_dpp v228, v228, v228 row_ror:8 row_mask:0xf bank_mask:0xf
    s_nop 1
    v_add_f32_dpp v228, v228, v228 row_ror:4 row_mask:0xf bank_mask:0xf
    s_nop 1
    v_add_f32_dpp v228, v228, v228 row_ror:2 row_mask:0xf bank_mask:0xf
    s_nop 1
    v_add_f32_dpp v228, v228, v228 row_ror:1 row_mask:0xf bank_mask:0xf
    v_mov_b32 v236, v228
    s_nop 1
    v_permlane32_swap_b32 v236, v228
    v_add_f32 v228, v236, v228
    v_mov_b32 v236, v228
    s_nop 1
    v_permlane16_swap_b32 v236, v228
    v_add_f32 v228, v236, v228
    v_fma_f32 v228, v228, s50, v227
    v_lshlrev_b32 v236, 16, v226
    v_and_b32 v237, 0xffff0000, v226
    s_waitcnt vmcnt(0)
L_chk:
    s_mov_b32 s54, 65536
L_poll:
    v_min_u32 v40, v199, v203
    v_min3_u32 v40, v40, v207, v211
    v_min3_u32 v40, v40, v215, v219
    v_min_u32 v40, v40, v223
    v_cmp_eq_u32 vcc, 0, v40
    s_sub_u32 s54, s54, 1
    s_cbranch_scc1 L_polled
    s_cbranch_vccz L_polled
    global_load_dwordx4 v[196:199], v229, s[40:41] sc0 sc1
    global_load_dwordx4 v[200:203], v230, s[40:41] sc0 sc1
    global_load_dwordx4 v[204:207], v231, s[40:41] sc0 sc1
    global_load_dwordx4 v[208:211], v232, s[40:41] sc0 sc1
    global_load_dwordx4 v[212:215], v233, s[40:41] sc0 sc1
    global_load_dwordx4 v[216:219], v234, s[40:41] sc0 sc1
    global_load_dwordx4 v[220:223], v235, s[40:41] sc0 sc1
    s_waitcnt vmcnt(0)
    s_branch L_poll
L_polled:
    v_max3_f32 v40, v194, v198, v228
    v_max3_f32 v40, v40, v202, v206
    v_max3_f32 v40, v40, v210, v214
    v_max3_f32 v40, v40, v218, v222
    v_sub_f32 v228, v228, v40
    v_sub_f32 v194, v194, v40
    v_sub_f32 v198, v198, v40
    v_sub_f32 v202, v202, v40
    v_sub_f32 v206, v206, v40
    v_sub_f32 v210, v210, v40
    v_sub_f32 v214, v214, v40
    v_sub_f32 v218, v218, v40
    v_sub_f32 v222, v222, v40
    v_exp_f32 v228, v228
    v_exp_f32 v194, v194
    v_exp_f32 v198, v198
    v_exp_f32 v202, v202
    v_exp_f32 v206, v206
    v_exp_f32 v210, v210
    v_exp_f32 v214, v214
    v_exp_f32 v218, v218
    v_exp_f32 v222, v222
    v_mul_f32 v236, v236, v228
    v_mul_f32 v237, v237, v228
    v_fma_f32 v228, v195, v194, v228
    v_pk_fma_f32 v[236:237], v[192:193], v[194:195], v[236:237] op_sel_hi:[1,0,1]
    v_fma_f32 v228, v199, v198, v228
    v_pk_fma_f32 v[236:237], v[196:197], v[198:199], v[236:237] op_sel_hi:[1,0,1]
    v_fma_f32 v228, v203, v202, v228
    v_pk_fma_f32 v[236:237], v[200:201], v[202:203], v[236:237] op_sel_hi:[1,0,1]
    v_fma_f32 v228, v207, v206, v228
    v_pk_fma_f32 v[236:237], v[204:205], v[206:207], v[236:237] op_sel_hi:[1,0,1]
    v_fma_f32 v228, v211, v210, v228
    v_pk_fma_f32 v[236:237], v[208:209], v[210:211], v[236:237] op_sel_hi:[1,0,1]
    v_fma_f32 v228, v215, v214, v228
    v_pk_fma_f32 v[236:237], v[212:213], v[214:215], v[236:237] op_sel_hi:[1,0,1]
    v_fma_f32 v228, v219, v218, v228
    v_pk_fma_f32 v[236:237], v[216:217], v[218:219], v[236:237] op_sel_hi:[1,0,1]
    v_fma_f32 v228, v223, v222, v228
    v_pk_fma_f32 v[236:237], v[220:221], v[222:223], v[236:237] op_sel_hi:[1,0,1]
    v_rcp_f32 v228, v228
    s_lshl_b32 s51, s56, 8
    v_add_u32 v40, s51, v7
    v_mul_f32 v236, v236, v228
    v_mul_f32 v237, v237, v228
    v_cvt_pk_bf16_f32 v236, v236, v237
    global_store_dword v40, v236, s[36:37]
L_fin:
L_end:
    s_endpgm
L_helper:
    s_load_dwordx2 s[40:41], s[0:1], 64
    v_and_b32 v0, 63, v0
    v_lshlrev_b32 v1, 4, v0
    s_lshl_b32 s53, s64, 3
    s_add_u32 s53, s53, s43
    s_lshl_b32 s53, s53, 10
    s_add_u32 s53, s53, 1048576
    v_add_u32 v228, s53, v1
    v_add_u32 v229, 8192, v228
    v_add_u32 v230, 16384, v228
    v_add_u32 v231, 24576, v228
    v_mov_b32 v236, 0
    v_mov_b32 v237, 0
    v_mov_b32 v238, 0
    v_mov_b32 v239, 0
    s_lshl_b32 s53, s42, 8
    v_mov_b32 v232, s53
    s_waitcnt lgkmcnt(0)
    global_store_dwordx4 v228, v[236:239], s[40:41] sc0 sc1
    global_store_dwordx4 v229, v[236:239], s[40:41] sc0 sc1
    global_store_dwordx4 v230, v[236:239], s[40:41] sc0 sc1
    global_store_dwordx4 v231, v[236:239], s[40:41] sc0 sc1
    s_cmp_lg_u32 s43, 0
    s_cbranch_scc1 L_nozc
    s_mov_b64 exec, 1
    global_store_dword v232, v236, s[40:41] sc0 sc1
    s_mov_b64 exec, -1
L_nozc:
    s_waitcnt vmcnt(0)
    s_lshl_b32 s52, s42, 3
    s_mov_b32 s72, 1
    s_atomic_add s72, s[38:39], s52
    s_waitcnt lgkmcnt(0)
    s_endpgm
.section .rodata,"a"
.p2align 6
.amdhsa_kernel standalone__tree_speculative_verify_tree_attention_over_candidate_token_tree__decode_kernel
  .amdhsa_next_free_vgpr 252
  .amdhsa_next_free_sgpr 76
  .amdhsa_accum_offset 252
  .amdhsa_group_segment_fixed_size 0
  .amdhsa_kernarg_size 72
  .amdhsa_user_sgpr_count 2
  .amdhsa_user_sgpr_kernarg_segment_ptr 1
  .amdhsa_system_sgpr_workgroup_id_x 1
  .amdhsa_float_denorm_mode_32 3
.end_amdhsa_kernel
```
